```python
import torch

def _softmax(x, axis=-1):
    return torch.softmax(x, dim=axis)

def _gelu(x):
    return torch.nn.functional.gelu(x, approximate='tanh')

def _silu(x):
    return torch.nn.functional.silu(x)

def _sigmoid(x):
    return torch.sigmoid(x)

def _layernorm(x, axis=-1, eps=1e-05):
    m = x.mean(dim=axis, keepdim=True)
    v = x.var(dim=axis, keepdim=True, unbiased=False)
    return (x - m) / torch.sqrt(v + eps)

def _scatter_add(tgt, idx, src, axis=0):
    return tgt.clone().index_add_(axis, idx, src)

def _segment_sum(src, seg, n):
    out = torch.zeros((n,) + src.shape[1:], dtype=src.dtype)
    return out.index_add_(0, seg, src)

def _pad(x, pw):
    flat = tuple((v for pair in reversed(pw) for v in pair))
    return torch.nn.functional.pad(x, flat)
kernel_name = 'adaLN_cond__sliding_block__glu_gated_geglu__prompt'

def setup_inputs():

    _w = lambda a: (lambda t: t.to(torch.bfloat16) if t.is_floating_point() else t)(torch.as_tensor(a))

    def _A_setup():
        B, S, D = (1, 2048, 640)
        return {'x': _w((lambda *s: torch.randn(*s, dtype=torch.bfloat16) * 0.05)(B, S, D)), 'wqkv': _w((lambda *s: torch.randn(*s, dtype=torch.bfloat16) * 0.05)(D, 3 * D)), 'wo': _w((lambda *s: torch.randn(*s, dtype=torch.bfloat16) * 0.05)(D, D))}
    _A_in = _A_setup()

    def _B_setup():
        B, S, Dm, Df = (1, 2048, 640, 1728)
        return {'x': _w((lambda *s: torch.randn(*s, dtype=torch.bfloat16) * 0.05)(B, S, Dm)), 'w_gate': _w((lambda *s: torch.randn(*s, dtype=torch.bfloat16) * 0.8)(Dm, Df) * Dm ** (-0.5)), 'w_up': _w((lambda *s: torch.randn(*s, dtype=torch.bfloat16) * 0.8)(Dm, Df) * Dm ** (-0.5)), 'w_down': _w((lambda *s: torch.randn(*s, dtype=torch.bfloat16) * 0.8)(Df, Dm) * Df ** (-0.5))}
    _B_in = _B_setup()
    return {'A_x': _A_in['x'], 'A_wqkv': _A_in['wqkv'], 'A_wo': _A_in['wo'], 'B_x': _B_in['x'], 'B_w_gate': _B_in['w_gate'], 'B_w_up': _B_in['w_up'], 'B_w_down': _B_in['w_down'], 'c': _w((lambda *s: torch.randn(*s, dtype=torch.bfloat16) * 0.2)(1, 640) * 8.0), 'w_mod': _w((lambda *s: torch.randn(*s, dtype=torch.bfloat16) * 0.2)(640, 6 * 640) * 640 ** (-0.5) * 8.0)}

def reference(A_x, A_wqkv, A_wo, B_x, B_w_gate, B_w_up, B_w_down, c, w_mod):

    def _A_ref(x, wqkv, wo):
        B, S, D = x.shape
        H = 32
        Dh = D // H
        W = 256
        qkv = (lambda x, *d: x.permute(*d))((x @ wqkv).reshape(B, S, 3, H, Dh), 2, 0, 3, 1, 4)
        q, k, v = (qkv[0], qkv[1], qkv[2])
        scores = torch.einsum('bhqd,bhkd->bhqk', q, k) * Dh ** (-0.5)
        idx = torch.arange(S)
        mask = (idx[:, None] - idx[None, :] >= 0) & (idx[:, None] - idx[None, :] < W)
        scores = torch.where(mask[None, None], scores, -1000000000.0)
        p = _softmax(scores, axis=-1)
        o = torch.einsum('bhqk,bhkd->bhqd', p, v)
        return (lambda x, *d: x.permute(*d))(o, 0, 2, 1, 3).reshape(B, S, D) @ wo

    def _B_ref(x, w_gate, w_up, w_down):
        g = torch.einsum('bsd,df->bsf', x, w_gate)
        u = torch.einsum('bsd,df->bsf', x, w_up)
        h = _gelu(g) * u
        return torch.einsum('bsf,fd->bsd', h, w_down)
    x = A_x
    mod = (_silu(c) @ w_mod).reshape(c.shape[0], 6, 1, -1)
    sa, ca, ga, sb, cb, gb = (mod[:, 0].clone(), mod[:, 1].clone(), mod[:, 2].clone(), mod[:, 3].clone(), mod[:, 4].clone(), mod[:, 5].clone())
    h = _layernorm(x, axis=-1) * (1 + ca) + sa
    x = x + ga * _A_ref(h, A_wqkv, A_wo)
    h = _layernorm(x, axis=-1) * (1 + cb) + sb
    x = x + gb * _B_ref(h, B_w_gate, B_w_up, B_w_down)
    return x
```

```asm
; @launch kernel=p0_kernel grid=(368,1,1) block=(256,1,1) lds=5120
; @launch kernel=p1_kernel grid=(192,1,1) block=(512,1,1) lds=156672
; @launch kernel=p2_kernel grid=(256,1,1) block=(512,1,1) lds=53504
; @launch kernel=p3_kernel grid=(251,1,1) block=(448,1,1) lds=118784
; @launch kernel=p4_kernel grid=(224,1,1) block=(768,1,1) lds=151552
; @launch kernel=p5_kernel grid=(224,1,1) block=(448,1,1) lds=114688
.amdgcn_target "amdgcn-amd-amdhsa--gfx950"
.text
.globl p0_kernel
.p2align 8
.type p0_kernel,@function
p0_kernel:
  s_cmp_ge_u32 s2, 368
  s_cbranch_scc1 p0_END
  s_load_dwordx2 s[4:5], s[0:1], 0
  s_load_dwordx2 s[6:7], s[0:1], 56
  s_load_dwordx2 s[8:9], s[0:1], 64
  s_load_dwordx2 s[10:11], s[0:1], 88
  s_load_dwordx2 s[44:45], s[0:1], 8
  v_lshrrev_b32 v1, 6, v0
  s_nop 0
  v_readfirstlane_b32 s3, v1
  v_and_b32 v1, 63, v0
  s_nop 3
  s_waitcnt lgkmcnt(0)
  s_mov_b32 s12, s4
  s_mov_b32 s13, s5
  s_mov_b32 s14, 0x280000
  s_mov_b32 s15, 0x00020000
  s_mov_b32 s16, s6
  s_mov_b32 s17, s7
  s_mov_b32 s18, 0x500
  s_mov_b32 s19, 0x00020000
  s_mov_b32 s20, s8
  s_mov_b32 s21, s9
  s_mov_b32 s22, 0x4b0000
  s_mov_b32 s23, 0x00020000
  s_mov_b32 s24, s10
  s_mov_b32 s25, s11
  s_mov_b32 s26, 0x8000
  s_mov_b32 s27, 0x00020000
  s_add_u32 s28, s10, 0x100000
  s_addc_u32 s29, s11, 0
  s_mov_b32 s30, 0x280000
  s_mov_b32 s31, 0x00020000
  s_cmp_ge_u32 s2, 240
  s_cbranch_scc1 p0_ln
  s_and_b32 s35, s2, 7
  s_mul_i32 s35, s35, 30
  s_lshr_b32 s36, s2, 3
  s_add_u32 s35, s35, s36
  s_lshl_b32 s36, s35, 5
  v_lshrrev_b32 v4, 1, v0
  v_and_b32 v5, 1, v0
  v_lshlrev_b32 v5, 4, v5
  s_movk_i32 s37, 7680
  v_mul_lo_u32 v6, v4, s37
  v_add_u32 v6, v6, v5
  v_add_u32 v6, s36, v6
  v_lshlrev_b32 v7, 1, v4
  buffer_load_ushort v28, v7, s[16:19], 0 offen offset:0
  buffer_load_ushort v29, v7, s[16:19], 0 offen offset:256
  buffer_load_ushort v30, v7, s[16:19], 0 offen offset:512
  buffer_load_ushort v31, v7, s[16:19], 0 offen offset:768
  buffer_load_ushort v32, v7, s[16:19], 0 offen offset:1024
  s_mov_b32 s38, 0
  buffer_load_dwordx4 v[8:11], v6, s[20:23], s38 offen
  s_mov_b32 s38, 983040
  buffer_load_dwordx4 v[12:15], v6, s[20:23], s38 offen
  s_mov_b32 s38, 1966080
  buffer_load_dwordx4 v[16:19], v6, s[20:23], s38 offen
  s_mov_b32 s38, 2949120
  buffer_load_dwordx4 v[20:23], v6, s[20:23], s38 offen
  s_mov_b32 s38, 3932160
  buffer_load_dwordx4 v[24:27], v6, s[20:23], s38 offen
  s_waitcnt vmcnt(5)
  s_mov_b32 s38, 0xbfb8aa3b
  v_lshlrev_b32 v28, 16, v28
  v_mul_f32 v33, s38, v28
  v_exp_f32 v33, v33
  s_nop 0
  v_add_f32 v33, 1.0, v33
  v_rcp_f32 v33, v33
  s_nop 0
  v_mul_f32 v28, v28, v33
  v_cvt_pk_bf16_f32 v28, v28, v28
  v_lshlrev_b32 v28, 16, v28
  v_lshlrev_b32 v29, 16, v29
  v_mul_f32 v33, s38, v29
  v_exp_f32 v33, v33
  s_nop 0
  v_add_f32 v33, 1.0, v33
  v_rcp_f32 v33, v33
  s_nop 0
  v_mul_f32 v29, v29, v33
  v_cvt_pk_bf16_f32 v29, v29, v29
  v_lshlrev_b32 v29, 16, v29
  v_lshlrev_b32 v30, 16, v30
  v_mul_f32 v33, s38, v30
  v_exp_f32 v33, v33
  s_nop 0
  v_add_f32 v33, 1.0, v33
  v_rcp_f32 v33, v33
  s_nop 0
  v_mul_f32 v30, v30, v33
  v_cvt_pk_bf16_f32 v30, v30, v30
  v_lshlrev_b32 v30, 16, v30
  v_lshlrev_b32 v31, 16, v31
  v_mul_f32 v33, s38, v31
  v_exp_f32 v33, v33
  s_nop 0
  v_add_f32 v33, 1.0, v33
  v_rcp_f32 v33, v33
  s_nop 0
  v_mul_f32 v31, v31, v33
  v_cvt_pk_bf16_f32 v31, v31, v31
  v_lshlrev_b32 v31, 16, v31
  v_lshlrev_b32 v32, 16, v32
  v_mul_f32 v33, s38, v32
  v_exp_f32 v33, v33
  s_nop 0
  v_add_f32 v33, 1.0, v33
  v_rcp_f32 v33, v33
  s_nop 0
  v_mul_f32 v32, v32, v33
  v_cvt_pk_bf16_f32 v32, v32, v32
  v_lshlrev_b32 v32, 16, v32
  v_mov_b32 v60, 0
  v_mov_b32 v61, 0
  v_mov_b32 v62, 0
  v_mov_b32 v63, 0
  v_mov_b32 v64, 0
  v_mov_b32 v65, 0
  v_mov_b32 v66, 0
  v_mov_b32 v67, 0
  s_waitcnt vmcnt(4)
  v_lshlrev_b32 v33, 16, v8
  v_and_b32 v34, 0xffff0000, v8
  v_fmac_f32 v60, v33, v28
  v_fmac_f32 v61, v34, v28
  v_lshlrev_b32 v33, 16, v9
  v_and_b32 v34, 0xffff0000, v9
  v_fmac_f32 v62, v33, v28
  v_fmac_f32 v63, v34, v28
  v_lshlrev_b32 v33, 16, v10
  v_and_b32 v34, 0xffff0000, v10
  v_fmac_f32 v64, v33, v28
  v_fmac_f32 v65, v34, v28
  v_lshlrev_b32 v33, 16, v11
  v_and_b32 v34, 0xffff0000, v11
  v_fmac_f32 v66, v33, v28
  v_fmac_f32 v67, v34, v28
  s_waitcnt vmcnt(3)
  v_lshlrev_b32 v33, 16, v12
  v_and_b32 v34, 0xffff0000, v12
  v_fmac_f32 v60, v33, v29
  v_fmac_f32 v61, v34, v29
  v_lshlrev_b32 v33, 16, v13
  v_and_b32 v34, 0xffff0000, v13
  v_fmac_f32 v62, v33, v29
  v_fmac_f32 v63, v34, v29
  v_lshlrev_b32 v33, 16, v14
  v_and_b32 v34, 0xffff0000, v14
  v_fmac_f32 v64, v33, v29
  v_fmac_f32 v65, v34, v29
  v_lshlrev_b32 v33, 16, v15
  v_and_b32 v34, 0xffff0000, v15
  v_fmac_f32 v66, v33, v29
  v_fmac_f32 v67, v34, v29
  s_waitcnt vmcnt(2)
  v_lshlrev_b32 v33, 16, v16
  v_and_b32 v34, 0xffff0000, v16
  v_fmac_f32 v60, v33, v30
  v_fmac_f32 v61, v34, v30
  v_lshlrev_b32 v33, 16, v17
  v_and_b32 v34, 0xffff0000, v17
  v_fmac_f32 v62, v33, v30
  v_fmac_f32 v63, v34, v30
  v_lshlrev_b32 v33, 16, v18
  v_and_b32 v34, 0xffff0000, v18
  v_fmac_f32 v64, v33, v30
  v_fmac_f32 v65, v34, v30
  v_lshlrev_b32 v33, 16, v19
  v_and_b32 v34, 0xffff0000, v19
  v_fmac_f32 v66, v33, v30
  v_fmac_f32 v67, v34, v30
  s_waitcnt vmcnt(1)
  v_lshlrev_b32 v33, 16, v20
  v_and_b32 v34, 0xffff0000, v20
  v_fmac_f32 v60, v33, v31
  v_fmac_f32 v61, v34, v31
  v_lshlrev_b32 v33, 16, v21
  v_and_b32 v34, 0xffff0000, v21
  v_fmac_f32 v62, v33, v31
  v_fmac_f32 v63, v34, v31
  v_lshlrev_b32 v33, 16, v22
  v_and_b32 v34, 0xffff0000, v22
  v_fmac_f32 v64, v33, v31
  v_fmac_f32 v65, v34, v31
  v_lshlrev_b32 v33, 16, v23
  v_and_b32 v34, 0xffff0000, v23
  v_fmac_f32 v66, v33, v31
  v_fmac_f32 v67, v34, v31
  s_waitcnt vmcnt(0)
  v_lshlrev_b32 v33, 16, v24
  v_and_b32 v34, 0xffff0000, v24
  v_fmac_f32 v60, v33, v32
  v_fmac_f32 v61, v34, v32
  v_lshlrev_b32 v33, 16, v25
  v_and_b32 v34, 0xffff0000, v25
  v_fmac_f32 v62, v33, v32
  v_fmac_f32 v63, v34, v32
  v_lshlrev_b32 v33, 16, v26
  v_and_b32 v34, 0xffff0000, v26
  v_fmac_f32 v64, v33, v32
  v_fmac_f32 v65, v34, v32
  v_lshlrev_b32 v33, 16, v27
  v_and_b32 v34, 0xffff0000, v27
  v_fmac_f32 v66, v33, v32
  v_fmac_f32 v67, v34, v32
  s_nop 1
  v_add_f32_dpp v60, v60, v60 row_ror:2 row_mask:0xf bank_mask:0xf
  v_add_f32_dpp v61, v61, v61 row_ror:2 row_mask:0xf bank_mask:0xf
  v_add_f32_dpp v62, v62, v62 row_ror:2 row_mask:0xf bank_mask:0xf
  v_add_f32_dpp v63, v63, v63 row_ror:2 row_mask:0xf bank_mask:0xf
  v_add_f32_dpp v64, v64, v64 row_ror:2 row_mask:0xf bank_mask:0xf
  v_add_f32_dpp v65, v65, v65 row_ror:2 row_mask:0xf bank_mask:0xf
  v_add_f32_dpp v66, v66, v66 row_ror:2 row_mask:0xf bank_mask:0xf
  v_add_f32_dpp v67, v67, v67 row_ror:2 row_mask:0xf bank_mask:0xf
  s_nop 1
  v_add_f32_dpp v60, v60, v60 row_ror:4 row_mask:0xf bank_mask:0xf
  v_add_f32_dpp v61, v61, v61 row_ror:4 row_mask:0xf bank_mask:0xf
  v_add_f32_dpp v62, v62, v62 row_ror:4 row_mask:0xf bank_mask:0xf
  v_add_f32_dpp v63, v63, v63 row_ror:4 row_mask:0xf bank_mask:0xf
  v_add_f32_dpp v64, v64, v64 row_ror:4 row_mask:0xf bank_mask:0xf
  v_add_f32_dpp v65, v65, v65 row_ror:4 row_mask:0xf bank_mask:0xf
  v_add_f32_dpp v66, v66, v66 row_ror:4 row_mask:0xf bank_mask:0xf
  v_add_f32_dpp v67, v67, v67 row_ror:4 row_mask:0xf bank_mask:0xf
  s_nop 1
  v_add_f32_dpp v60, v60, v60 row_ror:8 row_mask:0xf bank_mask:0xf
  v_add_f32_dpp v61, v61, v61 row_ror:8 row_mask:0xf bank_mask:0xf
  v_add_f32_dpp v62, v62, v62 row_ror:8 row_mask:0xf bank_mask:0xf
  v_add_f32_dpp v63, v63, v63 row_ror:8 row_mask:0xf bank_mask:0xf
  v_add_f32_dpp v64, v64, v64 row_ror:8 row_mask:0xf bank_mask:0xf
  v_add_f32_dpp v65, v65, v65 row_ror:8 row_mask:0xf bank_mask:0xf
  v_add_f32_dpp v66, v66, v66 row_ror:8 row_mask:0xf bank_mask:0xf
  v_add_f32_dpp v67, v67, v67 row_ror:8 row_mask:0xf bank_mask:0xf
  v_lshrrev_b32 v33, 4, v0
  v_lshlrev_b32 v33, 6, v33
  v_and_b32 v34, 1, v0
  v_lshlrev_b32 v34, 5, v34
  v_add_u32 v33, v33, v34
  v_and_b32 v34, 15, v0
  v_cmp_gt_u32 vcc, 2, v34
  s_and_saveexec_b64 s[38:39], vcc
  ds_write_b128 v33, v[60:63]
  ds_write_b128 v33, v[64:67] offset:16
  s_mov_b64 exec, s[38:39]
  s_waitcnt lgkmcnt(0)
  s_barrier
  s_cmp_lg_u32 s3, 0
  s_cbranch_scc1 p0_nomod
  v_and_b32 v34, 15, v1
  v_lshlrev_b32 v33, 2, v34
  ds_read_b32 v60, v33 offset:0
  ds_read_b32 v61, v33 offset:64
  ds_read_b32 v62, v33 offset:128
  ds_read_b32 v63, v33 offset:192
  ds_read_b32 v64, v33 offset:256
  ds_read_b32 v65, v33 offset:320
  ds_read_b32 v66, v33 offset:384
  ds_read_b32 v67, v33 offset:448
  ds_read_b32 v68, v33 offset:512
  ds_read_b32 v69, v33 offset:576
  ds_read_b32 v70, v33 offset:640
  ds_read_b32 v71, v33 offset:704
  ds_read_b32 v72, v33 offset:768
  ds_read_b32 v73, v33 offset:832
  ds_read_b32 v74, v33 offset:896
  ds_read_b32 v75, v33 offset:960
  s_waitcnt lgkmcnt(0)
  v_add_f32 v60, v60, v68
  v_add_f32 v61, v61, v69
  v_add_f32 v62, v62, v70
  v_add_f32 v63, v63, v71
  v_add_f32 v64, v64, v72
  v_add_f32 v65, v65, v73
  v_add_f32 v66, v66, v74
  v_add_f32 v67, v67, v75
  v_add_f32 v60, v60, v64
  v_add_f32 v61, v61, v65
  v_add_f32 v62, v62, v66
  v_add_f32 v63, v63, v67
  v_add_f32 v60, v60, v62
  v_add_f32 v61, v61, v63
  v_add_f32 v60, v60, v61
  v_cvt_pk_bf16_f32 v60, v60, v60
  v_lshlrev_b32 v60, 16, v60
  s_mul_i32 s37, s35, 1639
  s_lshr_b32 s37, s37, 16
  s_cmp_eq_u32 s37, 1
  s_cselect_b32 s38, 1, 0
  s_cmp_eq_u32 s37, 4
  s_cselect_b32 s38, 1, s38
  s_cmp_eq_u32 s38, 0
  s_cbranch_scc1 p0_m1
  v_add_f32 v60, 1.0, v60
  v_cvt_pk_bf16_f32 v60, v60, v60
  v_lshlrev_b32 v60, 16, v60
p0_m1:
  s_lshl_b32 s36, s35, 6
  v_add_u32 v33, s36, v33
  v_cmp_gt_u32 vcc, 16, v1
  s_and_saveexec_b64 s[40:41], vcc
  buffer_store_dword v60, v33, s[24:27], 0 offen
  s_cmp_lt_u32 s37, 2
  s_cbranch_scc0 p0_m3
  s_mul_i32 s39, s37, 2562
  s_lshl_b32 s36, s35, 6
  s_sub_u32 s36, s36, s39
  s_add_u32 s36, s36, 0x5002
  v_lshlrev_b32 v33, 2, v34
  v_add_u32 v33, s36, v33
  v_lshrrev_b32 v60, 16, v60
  buffer_store_short v60, v33, s[24:27], 0 offen
  s_branch p0_m2
  p0_m3:
  s_cmp_lt_u32 s37, 3
  s_cbranch_scc1 p0_m2
  s_cmp_eq_u32 s37, 5
  s_cbranch_scc1 p0_m2
  s_cmp_eq_u32 s37, 3
  s_cselect_b32 s38, 1280, 0
  s_mul_i32 s39, s37, 1280
  s_lshl_b32 s36, s35, 5
  s_sub_u32 s36, s36, s39
  s_add_u32 s36, s36, s38
  s_add_u32 s36, s36, 0x4000
  v_lshlrev_b32 v33, 1, v34
  v_add_u32 v33, s36, v33
  v_lshrrev_b32 v60, 16, v60
  buffer_store_short v60, v33, s[24:27], 0 offen
p0_m2:
  s_mov_b64 exec, s[40:41]
p0_nomod:
  s_branch p0_END2
p0_ln:
  s_and_b32 s33, s2, 3
  s_lshl_b32 s33, s33, 5
  s_lshr_b32 s34, s2, 2
  s_and_b32 s34, s34, 1
  s_lshl_b32 s34, s34, 4
  s_add_u32 s33, s33, s34
  s_sub_u32 s34, s2, 240
  s_lshr_b32 s34, s34, 3
  s_add_u32 s33, s33, s34
  s_lshl_b32 s33, s33, 4
  s_lshl_b32 s34, s3, 2
  s_add_u32 s33, s33, s34
  v_lshrrev_b32 v2, 4, v1
  v_add_u32 v2, s33, v2
  s_movk_i32 s34, 1280
  v_mul_lo_u32 v2, v2, s34
  v_and_b32 v3, 15, v1
  v_lshlrev_b32 v3, 4, v3
  v_add_u32 v2, v2, v3
  buffer_load_dwordx4 v[40:43], v2, s[12:15], 0 offen offset:0
  buffer_load_dwordx4 v[44:47], v2, s[12:15], 0 offen offset:256
  buffer_load_dwordx4 v[48:51], v2, s[12:15], 0 offen offset:512
  buffer_load_dwordx4 v[52:55], v2, s[12:15], 0 offen offset:768
  buffer_load_dwordx4 v[56:59], v2, s[12:15], 0 offen offset:1024
  s_mov_b32 s46, 2457600
  s_mov_b32 s47, 0x00020000
  s_sub_u32 s52, s2, 240
  s_lshr_b32 s52, s52, 3
  s_lshl_b32 s52, s52, 2
  s_add_u32 s52, s52, s3
  s_mul_i32 s52, s52, 38400
  s_lshr_b32 s53, s2, 2
  s_and_b32 s53, s53, 1
  s_mul_i32 s53, s53, 1920
  s_add_u32 s52, s52, s53
  v_min_u32 v35, 59, v1
  v_cmp_lt_u32 vcc, 29, v35
  v_lshlrev_b32 v35, 6, v35
  v_add_u32 v36, 1920, v35
  v_cndmask_b32 v35, v35, v36, vcc
  buffer_load_dword v30, v35, s[44:47], s52 offen
  s_add_u32 s52, s52, 7680
  buffer_load_dword v31, v35, s[44:47], s52 offen
  s_add_u32 s52, s52, 7680
  buffer_load_dword v32, v35, s[44:47], s52 offen
  s_add_u32 s52, s52, 7680
  buffer_load_dword v33, v35, s[44:47], s52 offen
  s_add_u32 s52, s52, 7680
  buffer_load_dword v34, v35, s[44:47], s52 offen
  s_add_u32 s52, s52, 7680
  s_waitcnt vmcnt(5)
  v_lshlrev_b32 v80, 16, v40
  v_and_b32 v81, 0xffff0000, v40
  v_lshlrev_b32 v82, 16, v41
  v_and_b32 v83, 0xffff0000, v41
  v_lshlrev_b32 v84, 16, v42
  v_and_b32 v85, 0xffff0000, v42
  v_lshlrev_b32 v86, 16, v43
  v_and_b32 v87, 0xffff0000, v43
  v_lshlrev_b32 v88, 16, v44
  v_and_b32 v89, 0xffff0000, v44
  v_lshlrev_b32 v90, 16, v45
  v_and_b32 v91, 0xffff0000, v45
  v_lshlrev_b32 v92, 16, v46
  v_and_b32 v93, 0xffff0000, v46
  v_lshlrev_b32 v94, 16, v47
  v_and_b32 v95, 0xffff0000, v47
  v_lshlrev_b32 v96, 16, v48
  v_and_b32 v97, 0xffff0000, v48
  v_lshlrev_b32 v98, 16, v49
  v_and_b32 v99, 0xffff0000, v49
  v_lshlrev_b32 v100, 16, v50
  v_and_b32 v101, 0xffff0000, v50
  v_lshlrev_b32 v102, 16, v51
  v_and_b32 v103, 0xffff0000, v51
  v_lshlrev_b32 v104, 16, v52
  v_and_b32 v105, 0xffff0000, v52
  v_lshlrev_b32 v106, 16, v53
  v_and_b32 v107, 0xffff0000, v53
  v_lshlrev_b32 v108, 16, v54
  v_and_b32 v109, 0xffff0000, v54
  v_lshlrev_b32 v110, 16, v55
  v_and_b32 v111, 0xffff0000, v55
  v_lshlrev_b32 v112, 16, v56
  v_and_b32 v113, 0xffff0000, v56
  v_lshlrev_b32 v114, 16, v57
  v_and_b32 v115, 0xffff0000, v57
  v_lshlrev_b32 v116, 16, v58
  v_and_b32 v117, 0xffff0000, v58
  v_lshlrev_b32 v118, 16, v59
  v_and_b32 v119, 0xffff0000, v59
  v_add_f32 v70, v80, v84
  v_add_f32 v71, v81, v85
  v_add_f32 v72, v82, v86
  v_add_f32 v73, v83, v87
  v_add_f32 v70, v70, v88
  v_add_f32 v71, v71, v89
  v_add_f32 v72, v72, v90
  v_add_f32 v73, v73, v91
  v_add_f32 v70, v70, v92
  v_add_f32 v71, v71, v93
  v_add_f32 v72, v72, v94
  v_add_f32 v73, v73, v95
  v_add_f32 v70, v70, v96
  v_add_f32 v71, v71, v97
  v_add_f32 v72, v72, v98
  v_add_f32 v73, v73, v99
  v_add_f32 v70, v70, v100
  v_add_f32 v71, v71, v101
  v_add_f32 v72, v72, v102
  v_add_f32 v73, v73, v103
  v_add_f32 v70, v70, v104
  v_add_f32 v71, v71, v105
  v_add_f32 v72, v72, v106
  v_add_f32 v73, v73, v107
  v_add_f32 v70, v70, v108
  v_add_f32 v71, v71, v109
  v_add_f32 v72, v72, v110
  v_add_f32 v73, v73, v111
  v_add_f32 v70, v70, v112
  v_add_f32 v71, v71, v113
  v_add_f32 v72, v72, v114
  v_add_f32 v73, v73, v115
  v_add_f32 v70, v70, v116
  v_add_f32 v71, v71, v117
  v_add_f32 v72, v72, v118
  v_add_f32 v73, v73, v119
  v_add_f32 v70, v70, v71
  v_add_f32 v72, v72, v73
  v_add_f32 v70, v70, v72
  s_nop 1
  v_add_f32_dpp v70, v70, v70 row_ror:1 row_mask:0xf bank_mask:0xf
  s_nop 1
  v_add_f32_dpp v70, v70, v70 row_ror:2 row_mask:0xf bank_mask:0xf
  s_nop 1
  v_add_f32_dpp v70, v70, v70 row_ror:4 row_mask:0xf bank_mask:0xf
  s_nop 1
  v_add_f32_dpp v70, v70, v70 row_ror:8 row_mask:0xf bank_mask:0xf
  s_mov_b32 s38, 0x3acccccd
  v_mul_f32 v70, s38, v70
  v_sub_f32 v80, v80, v70
  v_sub_f32 v81, v81, v70
  v_sub_f32 v82, v82, v70
  v_sub_f32 v83, v83, v70
  v_sub_f32 v84, v84, v70
  v_sub_f32 v85, v85, v70
  v_sub_f32 v86, v86, v70
  v_sub_f32 v87, v87, v70
  v_sub_f32 v88, v88, v70
  v_sub_f32 v89, v89, v70
  v_sub_f32 v90, v90, v70
  v_sub_f32 v91, v91, v70
  v_sub_f32 v92, v92, v70
  v_sub_f32 v93, v93, v70
  v_sub_f32 v94, v94, v70
  v_sub_f32 v95, v95, v70
  v_sub_f32 v96, v96, v70
  v_sub_f32 v97, v97, v70
  v_sub_f32 v98, v98, v70
  v_sub_f32 v99, v99, v70
  v_sub_f32 v100, v100, v70
  v_sub_f32 v101, v101, v70
  v_sub_f32 v102, v102, v70
  v_sub_f32 v103, v103, v70
  v_sub_f32 v104, v104, v70
  v_sub_f32 v105, v105, v70
  v_sub_f32 v106, v106, v70
  v_sub_f32 v107, v107, v70
  v_sub_f32 v108, v108, v70
  v_sub_f32 v109, v109, v70
  v_sub_f32 v110, v110, v70
  v_sub_f32 v111, v111, v70
  v_sub_f32 v112, v112, v70
  v_sub_f32 v113, v113, v70
  v_sub_f32 v114, v114, v70
  v_sub_f32 v115, v115, v70
  v_sub_f32 v116, v116, v70
  v_sub_f32 v117, v117, v70
  v_sub_f32 v118, v118, v70
  v_sub_f32 v119, v119, v70
  v_mul_f32 v72, v80, v80
  v_mul_f32 v73, v81, v81
  v_mul_f32 v74, v82, v82
  v_mul_f32 v75, v83, v83
  v_fmac_f32 v72, v84, v84
  v_fmac_f32 v73, v85, v85
  v_fmac_f32 v74, v86, v86
  v_fmac_f32 v75, v87, v87
  v_fmac_f32 v72, v88, v88
  v_fmac_f32 v73, v89, v89
  v_fmac_f32 v74, v90, v90
  v_fmac_f32 v75, v91, v91
  v_fmac_f32 v72, v92, v92
  v_fmac_f32 v73, v93, v93
  v_fmac_f32 v74, v94, v94
  v_fmac_f32 v75, v95, v95
  v_fmac_f32 v72, v96, v96
  v_fmac_f32 v73, v97, v97
  v_fmac_f32 v74, v98, v98
  v_fmac_f32 v75, v99, v99
  v_fmac_f32 v72, v100, v100
  v_fmac_f32 v73, v101, v101
  v_fmac_f32 v74, v102, v102
  v_fmac_f32 v75, v103, v103
  v_fmac_f32 v72, v104, v104
  v_fmac_f32 v73, v105, v105
  v_fmac_f32 v74, v106, v106
  v_fmac_f32 v75, v107, v107
  v_fmac_f32 v72, v108, v108
  v_fmac_f32 v73, v109, v109
  v_fmac_f32 v74, v110, v110
  v_fmac_f32 v75, v111, v111
  v_fmac_f32 v72, v112, v112
  v_fmac_f32 v73, v113, v113
  v_fmac_f32 v74, v114, v114
  v_fmac_f32 v75, v115, v115
  v_fmac_f32 v72, v116, v116
  v_fmac_f32 v73, v117, v117
  v_fmac_f32 v74, v118, v118
  v_fmac_f32 v75, v119, v119
  v_add_f32 v72, v72, v73
  v_add_f32 v74, v74, v75
  v_add_f32 v72, v72, v74
  s_nop 1
  v_add_f32_dpp v72, v72, v72 row_ror:1 row_mask:0xf bank_mask:0xf
  s_nop 1
  v_add_f32_dpp v72, v72, v72 row_ror:2 row_mask:0xf bank_mask:0xf
  s_nop 1
  v_add_f32_dpp v72, v72, v72 row_ror:4 row_mask:0xf bank_mask:0xf
  s_nop 1
  v_add_f32_dpp v72, v72, v72 row_ror:8 row_mask:0xf bank_mask:0xf
  v_mov_b32 v73, 0x3727c5ac
  v_fmac_f32 v73, s38, v72
  v_rsq_f32 v73, v73
  s_nop 0
  v_mul_f32 v80, v80, v73
  v_mul_f32 v81, v81, v73
  v_mul_f32 v82, v82, v73
  v_mul_f32 v83, v83, v73
  v_mul_f32 v84, v84, v73
  v_mul_f32 v85, v85, v73
  v_mul_f32 v86, v86, v73
  v_mul_f32 v87, v87, v73
  v_mul_f32 v88, v88, v73
  v_mul_f32 v89, v89, v73
  v_mul_f32 v90, v90, v73
  v_mul_f32 v91, v91, v73
  v_mul_f32 v92, v92, v73
  v_mul_f32 v93, v93, v73
  v_mul_f32 v94, v94, v73
  v_mul_f32 v95, v95, v73
  v_mul_f32 v96, v96, v73
  v_mul_f32 v97, v97, v73
  v_mul_f32 v98, v98, v73
  v_mul_f32 v99, v99, v73
  v_mul_f32 v100, v100, v73
  v_mul_f32 v101, v101, v73
  v_mul_f32 v102, v102, v73
  v_mul_f32 v103, v103, v73
  v_mul_f32 v104, v104, v73
  v_mul_f32 v105, v105, v73
  v_mul_f32 v106, v106, v73
  v_mul_f32 v107, v107, v73
  v_mul_f32 v108, v108, v73
  v_mul_f32 v109, v109, v73
  v_mul_f32 v110, v110, v73
  v_mul_f32 v111, v111, v73
  v_mul_f32 v112, v112, v73
  v_mul_f32 v113, v113, v73
  v_mul_f32 v114, v114, v73
  v_mul_f32 v115, v115, v73
  v_mul_f32 v116, v116, v73
  v_mul_f32 v117, v117, v73
  v_mul_f32 v118, v118, v73
  v_mul_f32 v119, v119, v73
  v_cvt_pk_bf16_f32 v40, v80, v81
  v_cvt_pk_bf16_f32 v41, v82, v83
  v_cvt_pk_bf16_f32 v42, v84, v85
  v_cvt_pk_bf16_f32 v43, v86, v87
  v_cvt_pk_bf16_f32 v44, v88, v89
  v_cvt_pk_bf16_f32 v45, v90, v91
  v_cvt_pk_bf16_f32 v46, v92, v93
  v_cvt_pk_bf16_f32 v47, v94, v95
  v_cvt_pk_bf16_f32 v48, v96, v97
  v_cvt_pk_bf16_f32 v49, v98, v99
  v_cvt_pk_bf16_f32 v50, v100, v101
  v_cvt_pk_bf16_f32 v51, v102, v103
  v_cvt_pk_bf16_f32 v52, v104, v105
  v_cvt_pk_bf16_f32 v53, v106, v107
  v_cvt_pk_bf16_f32 v54, v108, v109
  v_cvt_pk_bf16_f32 v55, v110, v111
  v_cvt_pk_bf16_f32 v56, v112, v113
  v_cvt_pk_bf16_f32 v57, v114, v115
  v_cvt_pk_bf16_f32 v58, v116, v117
  v_cvt_pk_bf16_f32 v59, v118, v119
  buffer_store_dwordx4 v[40:43], v2, s[28:31], 0 offen offset:0
  buffer_store_dwordx4 v[44:47], v2, s[28:31], 0 offen offset:256
  buffer_store_dwordx4 v[48:51], v2, s[28:31], 0 offen offset:512
  buffer_store_dwordx4 v[52:55], v2, s[28:31], 0 offen offset:768
  buffer_store_dwordx4 v[56:59], v2, s[28:31], 0 offen offset:1024
p0_END2:
  s_waitcnt vmcnt(0)
p0_END:
  s_endpgm
.section .rodata,"a"
.p2align 6
.amdhsa_kernel p0_kernel
  .amdhsa_next_free_vgpr 128
  .amdhsa_next_free_sgpr 102
  .amdhsa_accum_offset 128
  .amdhsa_group_segment_fixed_size 0
  .amdhsa_kernarg_size 96
  .amdhsa_user_sgpr_count 2
  .amdhsa_user_sgpr_kernarg_segment_ptr 1
  .amdhsa_system_sgpr_workgroup_id_x 1
.end_amdhsa_kernel
.text
.globl p1_kernel
.p2align 8
.type p1_kernel,@function
p1_kernel:
  s_cmp_ge_u32 s2, 192
  s_cbranch_scc1 p1_END
  s_load_dwordx2 s[4:5], s[0:1], 8
  s_load_dwordx2 s[6:7], s[0:1], 88
  s_load_dwordx2 s[20:21], s[0:1], 32
  s_load_dwordx2 s[24:25], s[0:1], 40
  s_load_dwordx2 s[28:29], s[0:1], 48
  v_lshrrev_b32 v1, 6, v0
  s_nop 0
  v_readfirstlane_b32 s3, v1
  v_and_b32 v1, 63, v0
  s_nop 3
  s_and_b32 s33, s2, 7
  s_lshr_b32 s34, s2, 3
  s_and_b32 s35, s33, 3
  s_lshl_b32 s35, s35, 2
  s_and_b32 s60, s34, 3
  s_add_u32 s60, s60, s35
  s_lshl_b32 s60, s60, 7
  s_lshr_b32 s33, s33, 2
  s_mul_i32 s33, s33, 6
  s_lshr_b32 s34, s34, 2
  s_add_u32 s61, s33, s34
  s_mul_i32 s37, s61, 320
  s_cmp_lt_u32 s3, 4
  s_cbranch_scc1 p1_comp
  s_mul_i32 s36, s60, 1280
  s_sub_u32 s43, s3, 4
  v_lshrrev_b32 v2, 3, v1
  s_lshl_b32 s47, s43, 3
  v_add_u32 v2, s47, v2
  v_lshrrev_b32 v3, 1, v2
  v_and_b32 v3, 7, v3
  v_and_b32 v4, 7, v1
  v_xor_b32 v3, v3, v4
  v_lshlrev_b32 v3, 4, v3
  s_mov_b32 s47, 1280
  v_mad_u32_u24 v2, v2, s47, v3
  v_add_u32 v8, s36, v2
  v_add_u32 v9, 40960, v8
  v_add_u32 v10, 81920, v8
  v_add_u32 v11, 122880, v8
  s_lshl_b32 s47, s43, 10
  v_lshlrev_b32 v4, 4, v1
  v_add_u32 v4, s47, v4
  s_mov_b32 s46, 52429
  s_mov_b32 s47, 3520
  v_add_u32 v2, 0, v4
  v_lshrrev_b32 v3, 6, v2
  v_mul_u32_u24 v3, s46, v3
  v_lshrrev_b32 v3, 18, v3
  v_mad_u32_u24 v2, v3, s47, v2
  v_add_u32 v12, s37, v2
  v_add_u32 v2, 4096, v4
  v_lshrrev_b32 v3, 6, v2
  v_mul_u32_u24 v3, s46, v3
  v_lshrrev_b32 v3, 18, v3
  v_mad_u32_u24 v2, v3, s47, v2
  v_add_u32 v13, s37, v2
  v_add_u32 v2, 8192, v4
  v_lshrrev_b32 v3, 6, v2
  v_mul_u32_u24 v3, s46, v3
  v_lshrrev_b32 v3, 18, v3
  v_mad_u32_u24 v2, v3, s47, v2
  v_add_u32 v14, s37, v2
  v_add_u32 v2, 12288, v4
  v_lshrrev_b32 v3, 6, v2
  v_mul_u32_u24 v3, s46, v3
  v_lshrrev_b32 v3, 18, v3
  v_mad_u32_u24 v2, v3, s47, v2
  v_add_u32 v15, s37, v2
  v_add_u32 v2, 16384, v4
  v_lshrrev_b32 v3, 6, v2
  v_mul_u32_u24 v3, s46, v3
  v_lshrrev_b32 v3, 18, v3
  v_mad_u32_u24 v2, v3, s47, v2
  v_add_u32 v16, s37, v2
  s_lshl_b32 s40, s43, 10
  s_mov_b32 s41, 0
  s_mov_b32 s42, 0
  s_mov_b32 s45, 0
  s_mov_b32 s44, 0
  v_subrev_u32 v3, 256, v0
  v_lshlrev_b32 v2, 4, v3
  s_waitcnt lgkmcnt(0)
  s_add_u32 s8, s6, 0x100000
  s_addc_u32 s9, s7, 0
  s_mov_b32 s10, 0x280000
  s_mov_b32 s11, 0x00020000
  s_mov_b32 s12, s4
  s_mov_b32 s13, s5
  s_mov_b32 s14, 0x258000
  s_mov_b32 s15, 0x00020000
  s_mov_b32 s16, s6
  s_mov_b32 s17, s7
  s_mov_b32 s18, 0x3c00
  s_mov_b32 s19, 0x00020000
  v_cmp_gt_u32 vcc, 160, v3
  s_and_saveexec_b64 s[48:49], vcc
  s_cbranch_execz p1_nt
  s_add_u32 m0, s40, 147456
  s_movk_i32 s50, 2560
  buffer_load_dwordx4 v2, s[16:19], s50 offen lds
  s_add_u32 m0, s40, 150016
  s_nop 0
  buffer_load_dwordx4 v2, s[16:19], 0 offen lds
p1_nt:
  s_mov_b64 exec, s[48:49]
  s_add_u32 s47, s40, 0
  s_add_u32 m0, s47, 0
  s_nop 0
  buffer_load_dwordx4 v8, s[8:11], s41 offen lds
  s_add_u32 m0, s47, 4096
  s_nop 0
  buffer_load_dwordx4 v9, s[8:11], s41 offen lds
  s_add_u32 m0, s47, 8192
  s_nop 0
  buffer_load_dwordx4 v10, s[8:11], s41 offen lds
  s_add_u32 m0, s47, 12288
  s_nop 0
  buffer_load_dwordx4 v11, s[8:11], s41 offen lds
  s_add_u32 m0, s47, 16384
  s_nop 0
  buffer_load_dwordx4 v12, s[12:15], s42 offen lds
  s_add_u32 m0, s47, 20480
  s_nop 0
  buffer_load_dwordx4 v13, s[12:15], s42 offen lds
  s_add_u32 m0, s47, 24576
  s_nop 0
  buffer_load_dwordx4 v14, s[12:15], s42 offen lds
  s_add_u32 m0, s47, 28672
  s_nop 0
  buffer_load_dwordx4 v15, s[12:15], s42 offen lds
  s_add_u32 m0, s47, 32768
  s_nop 0
  buffer_load_dwordx4 v16, s[12:15], s42 offen lds
  s_add_u32 s41, s41, 128
  s_add_u32 s42, s42, 245760
  s_add_u32 s47, s40, 36864
  s_add_u32 m0, s47, 0
  s_nop 0
  buffer_load_dwordx4 v8, s[8:11], s41 offen lds
  s_add_u32 m0, s47, 4096
  s_nop 0
  buffer_load_dwordx4 v9, s[8:11], s41 offen lds
  s_add_u32 m0, s47, 8192
  s_nop 0
  buffer_load_dwordx4 v10, s[8:11], s41 offen lds
  s_add_u32 m0, s47, 12288
  s_nop 0
  buffer_load_dwordx4 v11, s[8:11], s41 offen lds
  s_add_u32 m0, s47, 16384
  s_nop 0
  buffer_load_dwordx4 v12, s[12:15], s42 offen lds
  s_add_u32 m0, s47, 20480
  s_nop 0
  buffer_load_dwordx4 v13, s[12:15], s42 offen lds
  s_add_u32 m0, s47, 24576
  s_nop 0
  buffer_load_dwordx4 v14, s[12:15], s42 offen lds
  s_add_u32 m0, s47, 28672
  s_nop 0
  buffer_load_dwordx4 v15, s[12:15], s42 offen lds
  s_add_u32 m0, s47, 32768
  s_nop 0
  buffer_load_dwordx4 v16, s[12:15], s42 offen lds
  s_add_u32 s41, s41, 128
  s_add_u32 s42, s42, 245760
  s_waitcnt vmcnt(9)
  s_barrier
  s_add_u32 s47, s40, 73728
  s_add_u32 m0, s47, 0
  s_nop 0
  buffer_load_dwordx4 v8, s[8:11], s41 offen lds
  s_add_u32 m0, s47, 4096
  s_nop 0
  buffer_load_dwordx4 v9, s[8:11], s41 offen lds
  s_add_u32 m0, s47, 8192
  s_nop 0
  buffer_load_dwordx4 v10, s[8:11], s41 offen lds
  s_add_u32 m0, s47, 12288
  s_nop 0
  buffer_load_dwordx4 v11, s[8:11], s41 offen lds
  s_add_u32 m0, s47, 16384
  s_nop 0
  buffer_load_dwordx4 v12, s[12:15], s42 offen lds
  s_add_u32 m0, s47, 20480
  s_nop 0
  buffer_load_dwordx4 v13, s[12:15], s42 offen lds
  s_add_u32 m0, s47, 24576
  s_nop 0
  buffer_load_dwordx4 v14, s[12:15], s42 offen lds
  s_add_u32 m0, s47, 28672
  s_nop 0
  buffer_load_dwordx4 v15, s[12:15], s42 offen lds
  s_add_u32 m0, s47, 32768
  s_nop 0
  buffer_load_dwordx4 v16, s[12:15], s42 offen lds
  s_add_u32 s41, s41, 128
  s_add_u32 s42, s42, 245760
  s_mov_b32 s45, 110592
p1_ll_1:
  s_waitcnt vmcnt(9)
  s_barrier
  s_add_u32 s47, s40, s45
  s_add_u32 m0, s47, 0
  s_nop 0
  buffer_load_dwordx4 v8, s[8:11], s41 offen lds
  s_add_u32 m0, s47, 4096
  s_nop 0
  buffer_load_dwordx4 v9, s[8:11], s41 offen lds
  s_add_u32 m0, s47, 8192
  s_nop 0
  buffer_load_dwordx4 v10, s[8:11], s41 offen lds
  s_add_u32 m0, s47, 12288
  s_nop 0
  buffer_load_dwordx4 v11, s[8:11], s41 offen lds
  s_add_u32 m0, s47, 16384
  s_nop 0
  buffer_load_dwordx4 v12, s[12:15], s42 offen lds
  s_add_u32 m0, s47, 20480
  s_nop 0
  buffer_load_dwordx4 v13, s[12:15], s42 offen lds
  s_add_u32 m0, s47, 24576
  s_nop 0
  buffer_load_dwordx4 v14, s[12:15], s42 offen lds
  s_add_u32 m0, s47, 28672
  s_nop 0
  buffer_load_dwordx4 v15, s[12:15], s42 offen lds
  s_add_u32 m0, s47, 32768
  s_nop 0
  buffer_load_dwordx4 v16, s[12:15], s42 offen lds
  s_add_u32 s41, s41, 128
  s_add_u32 s42, s42, 245760
  s_add_u32 s45, s45, 36864
  s_cmp_eq_u32 s45, 147456
  s_cselect_b32 s45, 0, s45
  s_add_u32 s44, s44, 1
  s_cmp_lt_u32 s44, 7
  s_cbranch_scc1 p1_ll_1
  s_waitcnt vmcnt(9)
  s_barrier
  s_lshl_b32 s51, s2, 2
  s_add_u32 s51, s51, s43
  s_lshr_b32 s52, s51, 8
  s_and_b32 s51, s51, 255
  s_mul_i32 s51, s51, 9216
  s_cmp_eq_u32 s52, 1
  s_cbranch_scc0 p1_pfa
  s_mov_b64 s[20:21], s[24:25]
p1_pfa:
  s_cmp_eq_u32 s52, 2
  s_cbranch_scc0 p1_pfb
  s_mov_b64 s[20:21], s[28:29]
p1_pfb:
  s_mov_b32 s22, 2211840
  s_mov_b32 s23, 0x00020000
  s_add_u32 m0, s40, 152576
  v_lshlrev_b32 v2, 4, v1
  v_lshlrev_b32 v2, 6, v1
  buffer_load_dword v3, v2, s[20:23], s51 offen
  s_add_u32 s51, s51, 4096
  buffer_load_dword v4, v2, s[20:23], s51 offen
  s_add_u32 s51, s51, 4096
  buffer_load_dword v5, v2, s[20:23], s51 offen
  s_add_u32 s51, s51, 4096
  s_waitcnt vmcnt(3)
  s_barrier
  s_waitcnt vmcnt(0)
  s_endpgm
p1_comp:
  v_and_b32 v2, 31, v1
  s_lshl_b32 s47, s3, 5
  v_add_u32 v2, s47, v2
  v_lshrrev_b32 v3, 1, v2
  v_and_b32 v3, 7, v3
  v_lshrrev_b32 v4, 5, v1
  v_xor_b32 v3, v3, v4
  v_lshlrev_b32 v3, 4, v3
  v_lshl_add_u32 v176, v2, 7, v3
  v_xor_b32 v177, 32, v176
  v_xor_b32 v178, 64, v176
  v_xor_b32 v179, 96, v176
  v_lshlrev_b32 v2, 3, v4
  v_and_b32 v3, 15, v1
  v_lshrrev_b32 v3, 2, v3
  v_add_u32 v2, v2, v3
  v_mul_u32_u24 v2, 320, v2
  v_lshrrev_b32 v3, 4, v1
  v_and_b32 v3, 1, v3
  v_lshl_add_u32 v2, v3, 5, v2
  v_and_b32 v3, 3, v1
  v_lshl_add_u32 v2, v3, 3, v2
  v_add_u32 v180, 16384, v2
  v_xor_b32 v181, 64, v180
  v_lshlrev_b32 v230, 5, v4
  v_add_u32 v230, 147456, v230
  v_mov_b32 v231, 1.0
  s_mov_b32 s62, 0xffff
  s_movk_i32 s63, 0x3f80
  s_mov_b32 s45, 0
  s_mov_b32 s44, 0
  v_mov_b32 v8, 0
  v_mov_b32 v9, 0
  v_mov_b32 v10, 0
  v_mov_b32 v11, 0
  v_mov_b32 v12, 0
  v_mov_b32 v13, 0
  v_mov_b32 v14, 0
  v_mov_b32 v15, 0
  v_mov_b32 v16, 0
  v_mov_b32 v17, 0
  v_mov_b32 v18, 0
  v_mov_b32 v19, 0
  v_mov_b32 v20, 0
  v_mov_b32 v21, 0
  v_mov_b32 v22, 0
  v_mov_b32 v23, 0
  v_mov_b32 v24, 0
  v_mov_b32 v25, 0
  v_mov_b32 v26, 0
  v_mov_b32 v27, 0
  v_mov_b32 v28, 0
  v_mov_b32 v29, 0
  v_mov_b32 v30, 0
  v_mov_b32 v31, 0
  v_mov_b32 v32, 0
  v_mov_b32 v33, 0
  v_mov_b32 v34, 0
  v_mov_b32 v35, 0
  v_mov_b32 v36, 0
  v_mov_b32 v37, 0
  v_mov_b32 v38, 0
  v_mov_b32 v39, 0
  v_mov_b32 v40, 0
  v_mov_b32 v41, 0
  v_mov_b32 v42, 0
  v_mov_b32 v43, 0
  v_mov_b32 v44, 0
  v_mov_b32 v45, 0
  v_mov_b32 v46, 0
  v_mov_b32 v47, 0
  v_mov_b32 v48, 0
  v_mov_b32 v49, 0
  v_mov_b32 v50, 0
  v_mov_b32 v51, 0
  v_mov_b32 v52, 0
  v_mov_b32 v53, 0
  v_mov_b32 v54, 0
  v_mov_b32 v55, 0
  v_mov_b32 v56, 0
  v_mov_b32 v57, 0
  v_mov_b32 v58, 0
  v_mov_b32 v59, 0
  v_mov_b32 v60, 0
  v_mov_b32 v61, 0
  v_mov_b32 v62, 0
  v_mov_b32 v63, 0
  v_mov_b32 v64, 0
  v_mov_b32 v65, 0
  v_mov_b32 v66, 0
  v_mov_b32 v67, 0
  v_mov_b32 v68, 0
  v_mov_b32 v69, 0
  v_mov_b32 v70, 0
  v_mov_b32 v71, 0
  v_mov_b32 v72, 0
  v_mov_b32 v73, 0
  v_mov_b32 v74, 0
  v_mov_b32 v75, 0
  v_mov_b32 v76, 0
  v_mov_b32 v77, 0
  v_mov_b32 v78, 0
  v_mov_b32 v79, 0
  v_mov_b32 v80, 0
  v_mov_b32 v81, 0
  v_mov_b32 v82, 0
  v_mov_b32 v83, 0
  v_mov_b32 v84, 0
  v_mov_b32 v85, 0
  v_mov_b32 v86, 0
  v_mov_b32 v87, 0
  s_lshr_b32 s51, s61, 2
  s_cmp_eq_u32 s51, 2
  s_cselect_b32 s53, 48, 40
  s_waitcnt lgkmcnt(0)
  s_mul_i32 s54, s51, 3145728
  s_add_u32 s54, s54, 4194304
  s_add_u32 s20, s6, s54
  s_addc_u32 s21, s7, 0
  s_lshl_b32 s22, s53, 16
  s_mov_b32 s23, 0x00020000
  s_and_b32 s55, s61, 3
  s_lshl_b32 s55, s55, 14
  s_add_u32 s55, s55, s60
  s_lshl_b32 s56, s3, 5
  s_add_u32 s55, s55, s56
  s_mul_i32 s55, s55, s53
  s_mul_i32 s56, s3, 12288
  s_add_u32 s56, s56, 73728
  v_and_b32 v2, 31, v1
  v_lshrrev_b32 v3, 5, v1
  v_mul_u32_u24 v2, s53, v2
  v_add_u32 v2, s56, v2
  v_lshl_add_u32 v244, v3, 3, v2
  s_mul_i32 s57, s53, 32
  s_sub_u32 s57, s57, 32
  v_mad_u32_u24 v245, v3, s57, v2
  v_lshlrev_b32 v4, 4, v1
  v_add_u32 v246, s56, v4
  s_mov_b32 s57, 52429
  s_cmp_eq_u32 s51, 2
  s_cselect_b32 s57, 43691, s57
  s_cselect_b32 s58, 9, 8
  s_cselect_b32 s59, 17, 18
  s_mul_i32 s52, s53, 2016
  v_add_u32 v5, 0, v4
  v_lshrrev_b32 v6, s58, v5
  v_mul_u32_u24 v6, s57, v6
  v_lshrrev_b32 v6, s59, v6
  v_mad_u32_u24 v5, v6, s52, v5
  v_add_u32 v232, s55, v5
  v_add_u32 v5, 1024, v4
  v_lshrrev_b32 v6, s58, v5
  v_mul_u32_u24 v6, s57, v6
  v_lshrrev_b32 v6, s59, v6
  v_mad_u32_u24 v5, v6, s52, v5
  v_add_u32 v233, s55, v5
  v_add_u32 v5, 2048, v4
  v_lshrrev_b32 v6, s58, v5
  v_mul_u32_u24 v6, s57, v6
  v_lshrrev_b32 v6, s59, v6
  v_mad_u32_u24 v5, v6, s52, v5
  v_add_u32 v234, s55, v5
  v_add_u32 v5, 3072, v4
  v_lshrrev_b32 v6, s58, v5
  v_mul_u32_u24 v6, s57, v6
  v_lshrrev_b32 v6, s59, v6
  v_mad_u32_u24 v5, v6, s52, v5
  v_add_u32 v235, s55, v5
  v_add_u32 v5, 4096, v4
  v_lshrrev_b32 v6, s58, v5
  v_mul_u32_u24 v6, s57, v6
  v_lshrrev_b32 v6, s59, v6
  v_mad_u32_u24 v5, v6, s52, v5
  v_add_u32 v236, s55, v5
  v_add_u32 v5, 5120, v4
  v_lshrrev_b32 v6, s58, v5
  v_mul_u32_u24 v6, s57, v6
  v_lshrrev_b32 v6, s59, v6
  v_mad_u32_u24 v5, v6, s52, v5
  v_add_u32 v237, s55, v5
  v_add_u32 v5, 6144, v4
  v_lshrrev_b32 v6, s58, v5
  v_mul_u32_u24 v6, s57, v6
  v_lshrrev_b32 v6, s59, v6
  v_mad_u32_u24 v5, v6, s52, v5
  v_add_u32 v238, s55, v5
  v_add_u32 v5, 7168, v4
  v_lshrrev_b32 v6, s58, v5
  v_mul_u32_u24 v6, s57, v6
  v_lshrrev_b32 v6, s59, v6
  v_mad_u32_u24 v5, v6, s52, v5
  v_add_u32 v239, s55, v5
  v_add_u32 v5, 8192, v4
  v_lshrrev_b32 v6, s58, v5
  v_mul_u32_u24 v6, s57, v6
  v_lshrrev_b32 v6, s59, v6
  v_mad_u32_u24 v5, v6, s52, v5
  v_add_u32 v240, s55, v5
  v_add_u32 v5, 9216, v4
  v_lshrrev_b32 v6, s58, v5
  v_mul_u32_u24 v6, s57, v6
  v_lshrrev_b32 v6, s59, v6
  v_mad_u32_u24 v5, v6, s52, v5
  v_add_u32 v241, s55, v5
  v_add_u32 v5, 10240, v4
  v_lshrrev_b32 v6, s58, v5
  v_mul_u32_u24 v6, s57, v6
  v_lshrrev_b32 v6, s59, v6
  v_mad_u32_u24 v5, v6, s52, v5
  v_add_u32 v242, s55, v5
  v_add_u32 v5, 11264, v4
  v_lshrrev_b32 v6, s58, v5
  v_mul_u32_u24 v6, s57, v6
  v_lshrrev_b32 v6, s59, v6
  v_mad_u32_u24 v5, v6, s52, v5
  v_add_u32 v243, s55, v5
  v_mov_b32 v248, 0x3f80
  v_mov_b32 v249, 0
  s_barrier
  ds_read_b128 v[182:185], v176
  ds_read_b128 v[190:193], v230 offset:0
  ds_read_b128 v[194:197], v230 offset:16
  ds_read_b128 v[198:201], v230 offset:2560
  ds_read_b128 v[202:205], v230 offset:2576
  ds_read_b64_tr_b16 v[96:97], v180 offset:0
  ds_read_b64_tr_b16 v[98:99], v180 offset:1280
  ds_read_b64_tr_b16 v[100:101], v180 offset:64
  ds_read_b64_tr_b16 v[102:103], v180 offset:1344
  ds_read_b64_tr_b16 v[104:105], v180 offset:128
  ds_read_b64_tr_b16 v[106:107], v180 offset:1408
  ds_read_b64_tr_b16 v[108:109], v180 offset:192
  ds_read_b64_tr_b16 v[110:111], v180 offset:1472
  ds_read_b64_tr_b16 v[112:113], v180 offset:256
  ds_read_b64_tr_b16 v[114:115], v180 offset:1536
  s_waitcnt lgkmcnt(10)
  ds_read_b128 v[186:189], v177
  ds_read_b128 v[206:209], v230 offset:64
  ds_read_b128 v[210:213], v230 offset:80
  ds_read_b128 v[214:217], v230 offset:2624
  ds_read_b128 v[218:221], v230 offset:2640
  v_lshlrev_b32 v222, 16, v182
  v_and_b32 v223, 0xffff0000, v182
  v_lshlrev_b32 v224, 16, v183
  v_and_b32 v225, 0xffff0000, v183
  v_lshlrev_b32 v226, 16, v184
  v_and_b32 v227, 0xffff0000, v184
  v_lshlrev_b32 v228, 16, v185
  v_and_b32 v229, 0xffff0000, v185
  v_pk_fma_f32 v[222:223], v[222:223], v[190:191], v[198:199]
  v_pk_fma_f32 v[224:225], v[224:225], v[192:193], v[200:201]
  v_pk_fma_f32 v[226:227], v[226:227], v[194:195], v[202:203]
  v_pk_fma_f32 v[228:229], v[228:229], v[196:197], v[204:205]
  v_cvt_pk_bf16_f32 v88, v222, v223
  v_cvt_pk_bf16_f32 v89, v224, v225
  v_cvt_pk_bf16_f32 v90, v226, v227
  v_cvt_pk_bf16_f32 v91, v228, v229
  ds_read_b64_tr_b16 v[116:117], v180 offset:5120
  ds_read_b64_tr_b16 v[118:119], v180 offset:6400
  ds_read_b64_tr_b16 v[120:121], v180 offset:5184
  ds_read_b64_tr_b16 v[122:123], v180 offset:6464
  ds_read_b64_tr_b16 v[124:125], v180 offset:5248
  ds_read_b64_tr_b16 v[126:127], v180 offset:6528
  ds_read_b64_tr_b16 v[128:129], v180 offset:5312
  ds_read_b64_tr_b16 v[130:131], v180 offset:6592
  ds_read_b64_tr_b16 v[132:133], v180 offset:5376
  ds_read_b64_tr_b16 v[134:135], v180 offset:6656
p1_loop_2:
  s_waitcnt lgkmcnt(10)
  v_mfma_f32_32x32x16_bf16 v[8:23], v[96:99], v[88:91], v[8:23]
  ds_read_b128 v[182:185], v178
  ds_read_b128 v[190:193], v230 offset:128
  ds_read_b128 v[194:197], v230 offset:144
  ds_read_b128 v[198:201], v230 offset:2688
  ds_read_b128 v[202:205], v230 offset:2704
  v_lshlrev_b32 v222, 16, v186
  v_and_b32 v223, 0xffff0000, v186
  v_lshlrev_b32 v224, 16, v187
  v_and_b32 v225, 0xffff0000, v187
  v_mfma_f32_32x32x16_bf16 v[24:39], v[100:103], v[88:91], v[24:39]
  ds_read_b64_tr_b16 v[136:137], v180 offset:10240
  ds_read_b64_tr_b16 v[138:139], v180 offset:11520
  ds_read_b64_tr_b16 v[140:141], v180 offset:10304
  v_lshlrev_b32 v226, 16, v188
  v_and_b32 v227, 0xffff0000, v188
  v_lshlrev_b32 v228, 16, v189
  v_and_b32 v229, 0xffff0000, v189
  v_mfma_f32_32x32x16_bf16 v[40:55], v[104:107], v[88:91], v[40:55]
  ds_read_b64_tr_b16 v[142:143], v180 offset:11584
  ds_read_b64_tr_b16 v[144:145], v180 offset:10368
  ds_read_b64_tr_b16 v[146:147], v180 offset:11648
  v_pk_fma_f32 v[222:223], v[222:223], v[206:207], v[214:215]
  v_pk_fma_f32 v[224:225], v[224:225], v[208:209], v[216:217]
  v_pk_fma_f32 v[226:227], v[226:227], v[210:211], v[218:219]
  v_pk_fma_f32 v[228:229], v[228:229], v[212:213], v[220:221]
  v_mfma_f32_32x32x16_bf16 v[56:71], v[108:111], v[88:91], v[56:71]
  ds_read_b64_tr_b16 v[148:149], v180 offset:10432
  ds_read_b64_tr_b16 v[150:151], v180 offset:11712
  v_cvt_pk_bf16_f32 v92, v222, v223
  v_cvt_pk_bf16_f32 v93, v224, v225
  v_cvt_pk_bf16_f32 v94, v226, v227
  v_cvt_pk_bf16_f32 v95, v228, v229
  v_mfma_f32_32x32x16_bf16 v[72:87], v[112:115], v[88:91], v[72:87]
  ds_read_b64_tr_b16 v[152:153], v180 offset:10496
  ds_read_b64_tr_b16 v[154:155], v180 offset:11776
  s_waitcnt lgkmcnt(10)
  v_mfma_f32_32x32x16_bf16 v[8:23], v[116:119], v[92:95], v[8:23]
  ds_read_b128 v[186:189], v179
  ds_read_b128 v[206:209], v230 offset:192
  ds_read_b128 v[210:213], v230 offset:208
  ds_read_b128 v[214:217], v230 offset:2752
  ds_read_b128 v[218:221], v230 offset:2768
  v_lshlrev_b32 v222, 16, v182
  v_and_b32 v223, 0xffff0000, v182
  v_lshlrev_b32 v224, 16, v183
  v_and_b32 v225, 0xffff0000, v183
  v_mfma_f32_32x32x16_bf16 v[24:39], v[120:123], v[92:95], v[24:39]
  ds_read_b64_tr_b16 v[156:157], v180 offset:15360
  ds_read_b64_tr_b16 v[158:159], v180 offset:16640
  ds_read_b64_tr_b16 v[160:161], v180 offset:15424
  v_lshlrev_b32 v226, 16, v184
  v_and_b32 v227, 0xffff0000, v184
  v_lshlrev_b32 v228, 16, v185
  v_and_b32 v229, 0xffff0000, v185
  v_mfma_f32_32x32x16_bf16 v[40:55], v[124:127], v[92:95], v[40:55]
  ds_read_b64_tr_b16 v[162:163], v180 offset:16704
  ds_read_b64_tr_b16 v[164:165], v180 offset:15488
  ds_read_b64_tr_b16 v[166:167], v180 offset:16768
  v_pk_fma_f32 v[222:223], v[222:223], v[190:191], v[198:199]
  v_pk_fma_f32 v[224:225], v[224:225], v[192:193], v[200:201]
  v_pk_fma_f32 v[226:227], v[226:227], v[194:195], v[202:203]
  v_pk_fma_f32 v[228:229], v[228:229], v[196:197], v[204:205]
  v_mfma_f32_32x32x16_bf16 v[56:71], v[128:131], v[92:95], v[56:71]
  ds_read_b64_tr_b16 v[168:169], v180 offset:15552
  ds_read_b64_tr_b16 v[170:171], v180 offset:16832
  v_cvt_pk_bf16_f32 v88, v222, v223
  v_cvt_pk_bf16_f32 v89, v224, v225
  v_cvt_pk_bf16_f32 v90, v226, v227
  v_cvt_pk_bf16_f32 v91, v228, v229
  v_mfma_f32_32x32x16_bf16 v[72:87], v[132:135], v[92:95], v[72:87]
  ds_read_b64_tr_b16 v[172:173], v180 offset:15616
  ds_read_b64_tr_b16 v[174:175], v180 offset:16896
  s_waitcnt lgkmcnt(10)
  s_barrier
  s_add_u32 s46, s45, 36864
  s_cmp_eq_u32 s46, 147456
  s_cselect_b32 s46, 0, s46
  s_sub_u32 s47, s46, s45
  s_mov_b32 s45, s46
  v_mfma_f32_32x32x16_bf16 v[8:23], v[136:139], v[88:91], v[8:23]
  v_add_u32 v176, s47, v176
  v_add_u32 v177, s47, v177
  v_add_u32 v178, s47, v178
  v_add_u32 v179, s47, v179
  v_add_u32 v180, s47, v180
  v_add_u32 v230, 256, v230
  ds_read_b128 v[182:185], v176
  ds_read_b128 v[190:193], v230 offset:0
  ds_read_b128 v[194:197], v230 offset:16
  ds_read_b128 v[198:201], v230 offset:2560
  ds_read_b128 v[202:205], v230 offset:2576
  v_lshlrev_b32 v222, 16, v186
  v_and_b32 v223, 0xffff0000, v186
  v_lshlrev_b32 v224, 16, v187
  v_and_b32 v225, 0xffff0000, v187
  v_mfma_f32_32x32x16_bf16 v[24:39], v[140:143], v[88:91], v[24:39]
  ds_read_b64_tr_b16 v[96:97], v180 offset:0
  ds_read_b64_tr_b16 v[98:99], v180 offset:1280
  ds_read_b64_tr_b16 v[100:101], v180 offset:64
  v_lshlrev_b32 v226, 16, v188
  v_and_b32 v227, 0xffff0000, v188
  v_lshlrev_b32 v228, 16, v189
  v_and_b32 v229, 0xffff0000, v189
  v_mfma_f32_32x32x16_bf16 v[40:55], v[144:147], v[88:91], v[40:55]
  ds_read_b64_tr_b16 v[102:103], v180 offset:1344
  ds_read_b64_tr_b16 v[104:105], v180 offset:128
  ds_read_b64_tr_b16 v[106:107], v180 offset:1408
  v_pk_fma_f32 v[222:223], v[222:223], v[206:207], v[214:215]
  v_pk_fma_f32 v[224:225], v[224:225], v[208:209], v[216:217]
  v_pk_fma_f32 v[226:227], v[226:227], v[210:211], v[218:219]
  v_pk_fma_f32 v[228:229], v[228:229], v[212:213], v[220:221]
  v_mfma_f32_32x32x16_bf16 v[56:71], v[148:151], v[88:91], v[56:71]
  ds_read_b64_tr_b16 v[108:109], v180 offset:192
  ds_read_b64_tr_b16 v[110:111], v180 offset:1472
  v_cvt_pk_bf16_f32 v92, v222, v223
  v_cvt_pk_bf16_f32 v93, v224, v225
  v_cvt_pk_bf16_f32 v94, v226, v227
  v_cvt_pk_bf16_f32 v95, v228, v229
  v_mfma_f32_32x32x16_bf16 v[72:87], v[152:155], v[88:91], v[72:87]
  ds_read_b64_tr_b16 v[112:113], v180 offset:256
  ds_read_b64_tr_b16 v[114:115], v180 offset:1536
  s_waitcnt lgkmcnt(10)
  v_mfma_f32_32x32x16_bf16 v[8:23], v[156:159], v[92:95], v[8:23]
  ds_read_b128 v[186:189], v177
  ds_read_b128 v[206:209], v230 offset:64
  ds_read_b128 v[210:213], v230 offset:80
  ds_read_b128 v[214:217], v230 offset:2624
  ds_read_b128 v[218:221], v230 offset:2640
  v_lshlrev_b32 v222, 16, v182
  v_and_b32 v223, 0xffff0000, v182
  v_lshlrev_b32 v224, 16, v183
  v_and_b32 v225, 0xffff0000, v183
  v_mfma_f32_32x32x16_bf16 v[24:39], v[160:163], v[92:95], v[24:39]
  ds_read_b64_tr_b16 v[116:117], v180 offset:5120
  ds_read_b64_tr_b16 v[118:119], v180 offset:6400
  ds_read_b64_tr_b16 v[120:121], v180 offset:5184
  v_lshlrev_b32 v226, 16, v184
  v_and_b32 v227, 0xffff0000, v184
  v_lshlrev_b32 v228, 16, v185
  v_and_b32 v229, 0xffff0000, v185
  v_mfma_f32_32x32x16_bf16 v[40:55], v[164:167], v[92:95], v[40:55]
  ds_read_b64_tr_b16 v[122:123], v180 offset:6464
  ds_read_b64_tr_b16 v[124:125], v180 offset:5248
  ds_read_b64_tr_b16 v[126:127], v180 offset:6528
  v_pk_fma_f32 v[222:223], v[222:223], v[190:191], v[198:199]
  v_pk_fma_f32 v[224:225], v[224:225], v[192:193], v[200:201]
  v_pk_fma_f32 v[226:227], v[226:227], v[194:195], v[202:203]
  v_pk_fma_f32 v[228:229], v[228:229], v[196:197], v[204:205]
  v_mfma_f32_32x32x16_bf16 v[56:71], v[168:171], v[92:95], v[56:71]
  ds_read_b64_tr_b16 v[128:129], v180 offset:5312
  ds_read_b64_tr_b16 v[130:131], v180 offset:6592
  v_cvt_pk_bf16_f32 v88, v222, v223
  v_cvt_pk_bf16_f32 v89, v224, v225
  v_cvt_pk_bf16_f32 v90, v226, v227
  v_cvt_pk_bf16_f32 v91, v228, v229
  v_mfma_f32_32x32x16_bf16 v[72:87], v[172:175], v[92:95], v[72:87]
  ds_read_b64_tr_b16 v[132:133], v180 offset:5376
  ds_read_b64_tr_b16 v[134:135], v180 offset:6656
  s_add_u32 s44, s44, 1
  s_cmp_lt_u32 s44, 9
  s_cbranch_scc1 p1_loop_2
  s_waitcnt lgkmcnt(10)
  v_mfma_f32_32x32x16_bf16 v[8:23], v[96:99], v[88:91], v[8:23]
  ds_read_b128 v[182:185], v178
  ds_read_b128 v[190:193], v230 offset:128
  ds_read_b128 v[194:197], v230 offset:144
  ds_read_b128 v[198:201], v230 offset:2688
  ds_read_b128 v[202:205], v230 offset:2704
  v_lshlrev_b32 v222, 16, v186
  v_and_b32 v223, 0xffff0000, v186
  v_lshlrev_b32 v224, 16, v187
  v_and_b32 v225, 0xffff0000, v187
  v_mfma_f32_32x32x16_bf16 v[24:39], v[100:103], v[88:91], v[24:39]
  ds_read_b64_tr_b16 v[136:137], v180 offset:10240
  ds_read_b64_tr_b16 v[138:139], v180 offset:11520
  ds_read_b64_tr_b16 v[140:141], v180 offset:10304
  v_lshlrev_b32 v226, 16, v188
  v_and_b32 v227, 0xffff0000, v188
  v_lshlrev_b32 v228, 16, v189
  v_and_b32 v229, 0xffff0000, v189
  v_mfma_f32_32x32x16_bf16 v[40:55], v[104:107], v[88:91], v[40:55]
  ds_read_b64_tr_b16 v[142:143], v180 offset:11584
  ds_read_b64_tr_b16 v[144:145], v180 offset:10368
  ds_read_b64_tr_b16 v[146:147], v180 offset:11648
  v_pk_fma_f32 v[222:223], v[222:223], v[206:207], v[214:215]
  v_pk_fma_f32 v[224:225], v[224:225], v[208:209], v[216:217]
  v_pk_fma_f32 v[226:227], v[226:227], v[210:211], v[218:219]
  v_pk_fma_f32 v[228:229], v[228:229], v[212:213], v[220:221]
  v_mfma_f32_32x32x16_bf16 v[56:71], v[108:111], v[88:91], v[56:71]
  ds_read_b64_tr_b16 v[148:149], v180 offset:10432
  ds_read_b64_tr_b16 v[150:151], v180 offset:11712
  v_cvt_pk_bf16_f32 v92, v222, v223
  v_cvt_pk_bf16_f32 v93, v224, v225
  v_cvt_pk_bf16_f32 v94, v226, v227
  v_cvt_pk_bf16_f32 v95, v228, v229
  v_mfma_f32_32x32x16_bf16 v[72:87], v[112:115], v[88:91], v[72:87]
  ds_read_b64_tr_b16 v[152:153], v180 offset:10496
  ds_read_b64_tr_b16 v[154:155], v180 offset:11776
  s_waitcnt lgkmcnt(10)
  v_mfma_f32_32x32x16_bf16 v[8:23], v[116:119], v[92:95], v[8:23]
  ds_read_b128 v[186:189], v179
  ds_read_b128 v[206:209], v230 offset:192
  ds_read_b128 v[210:213], v230 offset:208
  ds_read_b128 v[214:217], v230 offset:2752
  ds_read_b128 v[218:221], v230 offset:2768
  v_lshlrev_b32 v222, 16, v182
  v_and_b32 v223, 0xffff0000, v182
  v_lshlrev_b32 v224, 16, v183
  v_and_b32 v225, 0xffff0000, v183
  v_mfma_f32_32x32x16_bf16 v[24:39], v[120:123], v[92:95], v[24:39]
  ds_read_b64_tr_b16 v[156:157], v180 offset:15360
  ds_read_b64_tr_b16 v[158:159], v180 offset:16640
  ds_read_b64_tr_b16 v[160:161], v180 offset:15424
  v_lshlrev_b32 v226, 16, v184
  v_and_b32 v227, 0xffff0000, v184
  v_lshlrev_b32 v228, 16, v185
  v_and_b32 v229, 0xffff0000, v185
  v_mfma_f32_32x32x16_bf16 v[40:55], v[124:127], v[92:95], v[40:55]
  ds_read_b64_tr_b16 v[162:163], v180 offset:16704
  ds_read_b64_tr_b16 v[164:165], v180 offset:15488
  ds_read_b64_tr_b16 v[166:167], v180 offset:16768
  v_pk_fma_f32 v[222:223], v[222:223], v[190:191], v[198:199]
  v_pk_fma_f32 v[224:225], v[224:225], v[192:193], v[200:201]
  v_pk_fma_f32 v[226:227], v[226:227], v[194:195], v[202:203]
  v_pk_fma_f32 v[228:229], v[228:229], v[196:197], v[204:205]
  v_mfma_f32_32x32x16_bf16 v[56:71], v[128:131], v[92:95], v[56:71]
  ds_read_b64_tr_b16 v[168:169], v180 offset:15552
  ds_read_b64_tr_b16 v[170:171], v180 offset:16832
  v_cvt_pk_bf16_f32 v88, v222, v223
  v_cvt_pk_bf16_f32 v89, v224, v225
  v_cvt_pk_bf16_f32 v90, v226, v227
  v_cvt_pk_bf16_f32 v91, v228, v229
  v_mfma_f32_32x32x16_bf16 v[72:87], v[132:135], v[92:95], v[72:87]
  ds_read_b64_tr_b16 v[172:173], v180 offset:15616
  ds_read_b64_tr_b16 v[174:175], v180 offset:16896
  s_waitcnt lgkmcnt(10)
  v_mfma_f32_32x32x16_bf16 v[8:23], v[136:139], v[88:91], v[8:23]
  v_lshlrev_b32 v222, 16, v186
  v_and_b32 v223, 0xffff0000, v186
  v_lshlrev_b32 v224, 16, v187
  v_and_b32 v225, 0xffff0000, v187
  v_mfma_f32_32x32x16_bf16 v[24:39], v[140:143], v[88:91], v[24:39]
  v_lshlrev_b32 v226, 16, v188
  v_and_b32 v227, 0xffff0000, v188
  v_lshlrev_b32 v228, 16, v189
  v_and_b32 v229, 0xffff0000, v189
  v_mfma_f32_32x32x16_bf16 v[40:55], v[144:147], v[88:91], v[40:55]
  v_pk_fma_f32 v[222:223], v[222:223], v[206:207], v[214:215]
  v_pk_fma_f32 v[224:225], v[224:225], v[208:209], v[216:217]
  v_pk_fma_f32 v[226:227], v[226:227], v[210:211], v[218:219]
  v_pk_fma_f32 v[228:229], v[228:229], v[212:213], v[220:221]
  v_mfma_f32_32x32x16_bf16 v[56:71], v[148:151], v[88:91], v[56:71]
  v_cvt_pk_bf16_f32 v92, v222, v223
  v_cvt_pk_bf16_f32 v93, v224, v225
  v_cvt_pk_bf16_f32 v94, v226, v227
  v_cvt_pk_bf16_f32 v95, v228, v229
  v_mfma_f32_32x32x16_bf16 v[72:87], v[152:155], v[88:91], v[72:87]
  s_waitcnt lgkmcnt(0)
  v_mfma_f32_32x32x16_bf16 v[8:23], v[156:159], v[92:95], v[8:23]
  v_mfma_f32_32x32x16_bf16 v[24:39], v[160:163], v[92:95], v[24:39]
  v_mfma_f32_32x32x16_bf16 v[40:55], v[164:167], v[92:95], v[40:55]
  v_mfma_f32_32x32x16_bf16 v[56:71], v[168:171], v[92:95], v[56:71]
  v_mfma_f32_32x32x16_bf16 v[72:87], v[172:175], v[92:95], v[72:87]
  s_nop 15
  v_lshrrev_b32 v3, 5, v1
  s_cmp_eq_u32 s51, 2
  s_cbranch_scc1 p1_v
  s_cmp_lg_u32 s51, 0
  s_cbranch_scc1 p1_nsc
  s_mov_b32 s58, 0x3ea52b5c
  s_mov_b32 s59, 0x3ea52b5c
  v_pk_mul_f32 v[8:9], v[8:9], s[58:59]
  v_pk_mul_f32 v[10:11], v[10:11], s[58:59]
  v_pk_mul_f32 v[12:13], v[12:13], s[58:59]
  v_pk_mul_f32 v[14:15], v[14:15], s[58:59]
  v_pk_mul_f32 v[16:17], v[16:17], s[58:59]
  v_pk_mul_f32 v[18:19], v[18:19], s[58:59]
  v_pk_mul_f32 v[20:21], v[20:21], s[58:59]
  v_pk_mul_f32 v[22:23], v[22:23], s[58:59]
  v_pk_mul_f32 v[24:25], v[24:25], s[58:59]
  v_pk_mul_f32 v[26:27], v[26:27], s[58:59]
  v_pk_mul_f32 v[28:29], v[28:29], s[58:59]
  v_pk_mul_f32 v[30:31], v[30:31], s[58:59]
  v_pk_mul_f32 v[32:33], v[32:33], s[58:59]
  v_pk_mul_f32 v[34:35], v[34:35], s[58:59]
  v_pk_mul_f32 v[36:37], v[36:37], s[58:59]
  v_pk_mul_f32 v[38:39], v[38:39], s[58:59]
  v_pk_mul_f32 v[40:41], v[40:41], s[58:59]
  v_pk_mul_f32 v[42:43], v[42:43], s[58:59]
  v_pk_mul_f32 v[44:45], v[44:45], s[58:59]
  v_pk_mul_f32 v[46:47], v[46:47], s[58:59]
  v_pk_mul_f32 v[48:49], v[48:49], s[58:59]
  v_pk_mul_f32 v[50:51], v[50:51], s[58:59]
  v_pk_mul_f32 v[52:53], v[52:53], s[58:59]
  v_pk_mul_f32 v[54:55], v[54:55], s[58:59]
  v_pk_mul_f32 v[56:57], v[56:57], s[58:59]
  v_pk_mul_f32 v[58:59], v[58:59], s[58:59]
  v_pk_mul_f32 v[60:61], v[60:61], s[58:59]
  v_pk_mul_f32 v[62:63], v[62:63], s[58:59]
  v_pk_mul_f32 v[64:65], v[64:65], s[58:59]
  v_pk_mul_f32 v[66:67], v[66:67], s[58:59]
  v_pk_mul_f32 v[68:69], v[68:69], s[58:59]
  v_pk_mul_f32 v[70:71], v[70:71], s[58:59]
  v_pk_mul_f32 v[72:73], v[72:73], s[58:59]
  v_pk_mul_f32 v[74:75], v[74:75], s[58:59]
  v_pk_mul_f32 v[76:77], v[76:77], s[58:59]
  v_pk_mul_f32 v[78:79], v[78:79], s[58:59]
  v_pk_mul_f32 v[80:81], v[80:81], s[58:59]
  v_pk_mul_f32 v[82:83], v[82:83], s[58:59]
  v_pk_mul_f32 v[84:85], v[84:85], s[58:59]
  v_pk_mul_f32 v[86:87], v[86:87], s[58:59]
p1_nsc:
  v_cvt_pk_bf16_f32 v96, v8, v9
  v_cvt_pk_bf16_f32 v97, v10, v11
  ds_write_b64 v244, v[96:97] offset:0
  v_cvt_pk_bf16_f32 v98, v12, v13
  v_cvt_pk_bf16_f32 v99, v14, v15
  ds_write_b64 v244, v[98:99] offset:16
  v_cvt_pk_bf16_f32 v100, v16, v17
  v_cvt_pk_bf16_f32 v101, v18, v19
  ds_write_b64 v245, v[100:101] offset:32
  v_cvt_pk_bf16_f32 v102, v20, v21
  v_cvt_pk_bf16_f32 v103, v22, v23
  ds_write_b64 v244, v[102:103] offset:1288
  v_cvt_pk_bf16_f32 v104, v24, v25
  v_cvt_pk_bf16_f32 v105, v26, v27
  ds_write_b64 v244, v[104:105] offset:1304
  v_cvt_pk_bf16_f32 v106, v28, v29
  v_cvt_pk_bf16_f32 v107, v30, v31
  ds_write_b64 v244, v[106:107] offset:2560
  v_cvt_pk_bf16_f32 v108, v32, v33
  v_cvt_pk_bf16_f32 v109, v34, v35
  ds_write_b64 v244, v[108:109] offset:2576
  v_cvt_pk_bf16_f32 v110, v36, v37
  v_cvt_pk_bf16_f32 v111, v38, v39
  ds_write_b64 v245, v[110:111] offset:2592
  v_cvt_pk_bf16_f32 v112, v40, v41
  v_cvt_pk_bf16_f32 v113, v42, v43
  ds_write_b64 v244, v[112:113] offset:3848
  v_cvt_pk_bf16_f32 v114, v44, v45
  v_cvt_pk_bf16_f32 v115, v46, v47
  ds_write_b64 v244, v[114:115] offset:3864
  v_cvt_pk_bf16_f32 v116, v48, v49
  v_cvt_pk_bf16_f32 v117, v50, v51
  ds_write_b64 v244, v[116:117] offset:5120
  v_cvt_pk_bf16_f32 v118, v52, v53
  v_cvt_pk_bf16_f32 v119, v54, v55
  ds_write_b64 v244, v[118:119] offset:5136
  v_cvt_pk_bf16_f32 v120, v56, v57
  v_cvt_pk_bf16_f32 v121, v58, v59
  ds_write_b64 v245, v[120:121] offset:5152
  v_cvt_pk_bf16_f32 v122, v60, v61
  v_cvt_pk_bf16_f32 v123, v62, v63
  ds_write_b64 v244, v[122:123] offset:6408
  v_cvt_pk_bf16_f32 v124, v64, v65
  v_cvt_pk_bf16_f32 v125, v66, v67
  ds_write_b64 v244, v[124:125] offset:6424
  v_cvt_pk_bf16_f32 v126, v68, v69
  v_cvt_pk_bf16_f32 v127, v70, v71
  ds_write_b64 v244, v[126:127] offset:7680
  v_cvt_pk_bf16_f32 v96, v72, v73
  v_cvt_pk_bf16_f32 v97, v74, v75
  ds_write_b64 v244, v[96:97] offset:7696
  v_cvt_pk_bf16_f32 v98, v76, v77
  v_cvt_pk_bf16_f32 v99, v78, v79
  ds_write_b64 v245, v[98:99] offset:7712
  v_cvt_pk_bf16_f32 v100, v80, v81
  v_cvt_pk_bf16_f32 v101, v82, v83
  ds_write_b64 v244, v[100:101] offset:8968
  v_cvt_pk_bf16_f32 v102, v84, v85
  v_cvt_pk_bf16_f32 v103, v86, v87
  ds_write_b64 v244, v[102:103] offset:8984
  s_waitcnt lgkmcnt(0)
  ds_read_b128 v[8:11], v246 offset:0
  ds_read_b128 v[12:15], v246 offset:1024
  ds_read_b128 v[16:19], v246 offset:2048
  ds_read_b128 v[20:23], v246 offset:3072
  ds_read_b128 v[24:27], v246 offset:4096
  ds_read_b128 v[28:31], v246 offset:5120
  ds_read_b128 v[32:35], v246 offset:6144
  ds_read_b128 v[36:39], v246 offset:7168
  ds_read_b128 v[40:43], v246 offset:8192
  ds_read_b128 v[44:47], v246 offset:9216
  s_waitcnt lgkmcnt(9)
  buffer_store_dwordx4 v[8:11], v232, s[20:23], 0 offen
  s_waitcnt lgkmcnt(8)
  buffer_store_dwordx4 v[12:15], v233, s[20:23], 0 offen
  s_waitcnt lgkmcnt(7)
  buffer_store_dwordx4 v[16:19], v234, s[20:23], 0 offen
  s_waitcnt lgkmcnt(6)
  buffer_store_dwordx4 v[20:23], v235, s[20:23], 0 offen
  s_waitcnt lgkmcnt(5)
  buffer_store_dwordx4 v[24:27], v236, s[20:23], 0 offen
  s_waitcnt lgkmcnt(4)
  buffer_store_dwordx4 v[28:31], v237, s[20:23], 0 offen
  s_waitcnt lgkmcnt(3)
  buffer_store_dwordx4 v[32:35], v238, s[20:23], 0 offen
  s_waitcnt lgkmcnt(2)
  buffer_store_dwordx4 v[36:39], v239, s[20:23], 0 offen
  s_waitcnt lgkmcnt(1)
  buffer_store_dwordx4 v[40:43], v240, s[20:23], 0 offen
  s_waitcnt lgkmcnt(0)
  buffer_store_dwordx4 v[44:47], v241, s[20:23], 0 offen
  s_branch p1_fin
p1_v:
  v_cvt_pk_bf16_f32 v96, v8, v9
  v_cvt_pk_bf16_f32 v97, v10, v11
  ds_write_b64 v244, v[96:97] offset:0
  v_cvt_pk_bf16_f32 v98, v12, v13
  v_cvt_pk_bf16_f32 v99, v14, v15
  ds_write_b64 v244, v[98:99] offset:16
  v_cvt_pk_bf16_f32 v100, v16, v17
  v_cvt_pk_bf16_f32 v101, v18, v19
  ds_write_b64 v245, v[100:101] offset:32
  v_cvt_pk_bf16_f32 v102, v20, v21
  v_cvt_pk_bf16_f32 v103, v22, v23
  ds_write_b64 v244, v[102:103] offset:1544
  v_cvt_pk_bf16_f32 v104, v24, v25
  v_cvt_pk_bf16_f32 v105, v26, v27
  ds_write_b64 v244, v[104:105] offset:1560
  v_cvt_pk_bf16_f32 v106, v28, v29
  v_cvt_pk_bf16_f32 v107, v30, v31
  ds_write_b64 v244, v[106:107] offset:3072
  v_cvt_pk_bf16_f32 v108, v32, v33
  v_cvt_pk_bf16_f32 v109, v34, v35
  ds_write_b64 v244, v[108:109] offset:3088
  v_cvt_pk_bf16_f32 v110, v36, v37
  v_cvt_pk_bf16_f32 v111, v38, v39
  ds_write_b64 v245, v[110:111] offset:3104
  v_cvt_pk_bf16_f32 v112, v40, v41
  v_cvt_pk_bf16_f32 v113, v42, v43
  ds_write_b64 v244, v[112:113] offset:4616
  v_cvt_pk_bf16_f32 v114, v44, v45
  v_cvt_pk_bf16_f32 v115, v46, v47
  ds_write_b64 v244, v[114:115] offset:4632
  v_cvt_pk_bf16_f32 v116, v48, v49
  v_cvt_pk_bf16_f32 v117, v50, v51
  ds_write_b64 v244, v[116:117] offset:6144
  v_cvt_pk_bf16_f32 v118, v52, v53
  v_cvt_pk_bf16_f32 v119, v54, v55
  ds_write_b64 v244, v[118:119] offset:6160
  v_cvt_pk_bf16_f32 v120, v56, v57
  v_cvt_pk_bf16_f32 v121, v58, v59
  ds_write_b64 v245, v[120:121] offset:6176
  v_cvt_pk_bf16_f32 v122, v60, v61
  v_cvt_pk_bf16_f32 v123, v62, v63
  ds_write_b64 v244, v[122:123] offset:7688
  v_cvt_pk_bf16_f32 v124, v64, v65
  v_cvt_pk_bf16_f32 v125, v66, v67
  ds_write_b64 v244, v[124:125] offset:7704
  v_cvt_pk_bf16_f32 v126, v68, v69
  v_cvt_pk_bf16_f32 v127, v70, v71
  ds_write_b64 v244, v[126:127] offset:9216
  v_cvt_pk_bf16_f32 v96, v72, v73
  v_cvt_pk_bf16_f32 v97, v74, v75
  ds_write_b64 v244, v[96:97] offset:9232
  v_cvt_pk_bf16_f32 v98, v76, v77
  v_cvt_pk_bf16_f32 v99, v78, v79
  ds_write_b64 v245, v[98:99] offset:9248
  v_cvt_pk_bf16_f32 v100, v80, v81
  v_cvt_pk_bf16_f32 v101, v82, v83
  ds_write_b64 v244, v[100:101] offset:10760
  v_cvt_pk_bf16_f32 v102, v84, v85
  v_cvt_pk_bf16_f32 v103, v86, v87
  ds_write_b64 v244, v[102:103] offset:10776
  v_mul_u32_u24 v5, 6136, v3
  v_add_u32 v5, v5, v244
  ds_write_b64 v5, v[248:249] offset:40
  ds_write_b64 v5, v[248:249] offset:1576
  ds_write_b64 v5, v[248:249] offset:3112
  ds_write_b64 v5, v[248:249] offset:4648
  s_waitcnt lgkmcnt(0)
  ds_read_b128 v[8:11], v246 offset:0
  ds_read_b128 v[12:15], v246 offset:1024
  ds_read_b128 v[16:19], v246 offset:2048
  ds_read_b128 v[20:23], v246 offset:3072
  ds_read_b128 v[24:27], v246 offset:4096
  ds_read_b128 v[28:31], v246 offset:5120
  ds_read_b128 v[32:35], v246 offset:6144
  ds_read_b128 v[36:39], v246 offset:7168
  ds_read_b128 v[40:43], v246 offset:8192
  ds_read_b128 v[44:47], v246 offset:9216
  ds_read_b128 v[48:51], v246 offset:10240
  ds_read_b128 v[52:55], v246 offset:11264
  s_waitcnt lgkmcnt(11)
  buffer_store_dwordx4 v[8:11], v232, s[20:23], 0 offen
  s_waitcnt lgkmcnt(10)
  buffer_store_dwordx4 v[12:15], v233, s[20:23], 0 offen
  s_waitcnt lgkmcnt(9)
  buffer_store_dwordx4 v[16:19], v234, s[20:23], 0 offen
  s_waitcnt lgkmcnt(8)
  buffer_store_dwordx4 v[20:23], v235, s[20:23], 0 offen
  s_waitcnt lgkmcnt(7)
  buffer_store_dwordx4 v[24:27], v236, s[20:23], 0 offen
  s_waitcnt lgkmcnt(6)
  buffer_store_dwordx4 v[28:31], v237, s[20:23], 0 offen
  s_waitcnt lgkmcnt(5)
  buffer_store_dwordx4 v[32:35], v238, s[20:23], 0 offen
  s_waitcnt lgkmcnt(4)
  buffer_store_dwordx4 v[36:39], v239, s[20:23], 0 offen
  s_waitcnt lgkmcnt(3)
  buffer_store_dwordx4 v[40:43], v240, s[20:23], 0 offen
  s_waitcnt lgkmcnt(2)
  buffer_store_dwordx4 v[44:47], v241, s[20:23], 0 offen
  s_waitcnt lgkmcnt(1)
  buffer_store_dwordx4 v[48:51], v242, s[20:23], 0 offen
  s_waitcnt lgkmcnt(0)
  buffer_store_dwordx4 v[52:55], v243, s[20:23], 0 offen
p1_fin:
p1_END:
  s_endpgm
.section .rodata,"a"
.p2align 6
.amdhsa_kernel p1_kernel
  .amdhsa_next_free_vgpr 250
  .amdhsa_next_free_sgpr 102
  .amdhsa_accum_offset 252
  .amdhsa_group_segment_fixed_size 0
  .amdhsa_kernarg_size 96
  .amdhsa_user_sgpr_count 2
  .amdhsa_user_sgpr_kernarg_segment_ptr 1
  .amdhsa_system_sgpr_workgroup_id_x 1
.end_amdhsa_kernel
.text
.globl p2_kernel
.p2align 8
.type p2_kernel,@function
p2_kernel:
  s_cmp_ge_u32 s2, 256
  s_cbranch_scc1 p2_END
  s_load_dwordx2 s[6:7], s[0:1], 88
  s_load_dwordx2 s[24:25], s[0:1], 32
  s_load_dwordx2 s[28:29], s[0:1], 40
  s_load_dwordx2 s[52:53], s[0:1], 48
  s_load_dwordx2 s[56:57], s[0:1], 16
  v_lshrrev_b32 v1, 6, v0
  s_nop 0
  v_readfirstlane_b32 s3, v1
  v_and_b32 v1, 63, v0
  s_nop 3
  s_and_b32 s33, s2, 7
  s_lshl_b32 s33, s33, 2
  s_lshr_b32 s34, s2, 3
  s_and_b32 s34, s34, 3
  s_add_u32 s33, s33, s34
  s_lshr_b32 s34, s2, 5
  s_mul_i32 s36, s33, 81920
  s_mul_i32 s39, s34, 10240
  s_add_u32 s36, s36, s39
  s_cmp_eq_u32 s34, 0
  s_cselect_b32 s39, 0, 10240
  s_sub_u32 s35, s36, s39
  s_mul_i32 s38, s33, 98304
  s_mul_i32 s39, s34, 12288
  s_add_u32 s38, s38, s39
  s_cmp_eq_u32 s34, 0
  s_cselect_b32 s39, 0, 12288
  s_sub_u32 s37, s38, s39
  v_lshlrev_b32 v2, 4, v1
  s_waitcnt lgkmcnt(0)
  s_add_u32 s12, s6, 0x700000
  s_addc_u32 s13, s7, 0
  s_mov_b32 s14, 0x280000
  s_mov_b32 s15, 0x00020000
  s_add_u32 s40, s3, 0
  s_lshl_b32 s41, s40, 10
  s_add_u32 m0, s41, 0
  s_cmp_lt_u32 s40, 10
  s_cselect_b32 s42, s35, s36
  s_cselect_b32 s43, 0, 10240
  s_add_u32 s42, s42, s41
  s_sub_u32 s42, s42, s43
  buffer_load_dwordx4 v2, s[12:15], s42 offen lds
  s_add_u32 s40, s3, 8
  s_lshl_b32 s41, s40, 10
  s_add_u32 m0, s41, 0
  s_cmp_lt_u32 s40, 10
  s_cselect_b32 s42, s35, s36
  s_cselect_b32 s43, 0, 10240
  s_add_u32 s42, s42, s41
  s_sub_u32 s42, s42, s43
  buffer_load_dwordx4 v2, s[12:15], s42 offen lds
  s_cmp_ge_u32 s3, 4
  s_cbranch_scc1 p2_k3
  s_add_u32 s40, s3, 16
  s_lshl_b32 s41, s40, 10
  s_add_u32 m0, s41, 0
  s_cmp_lt_u32 s40, 10
  s_cselect_b32 s42, s35, s36
  s_cselect_b32 s43, 0, 10240
  s_add_u32 s42, s42, s41
  s_sub_u32 s42, s42, s43
  buffer_load_dwordx4 v2, s[12:15], s42 offen lds
p2_k3:
  s_add_u32 s8, s6, 0x400000
  s_addc_u32 s9, s7, 0
  s_mov_b32 s10, 0x280000
  s_mov_b32 s11, 0x00020000
  s_add_u32 s16, s6, 0xa00000
  s_addc_u32 s17, s7, 0
  s_mov_b32 s18, 0x300000
  s_mov_b32 s19, 0x00020000
  s_add_u32 s20, s6, 0xe00000
  s_addc_u32 s21, s7, 0
  s_mov_b32 s22, 0x280000
  s_mov_b32 s23, 0x00020000
  s_lshl_b32 s40, s33, 11
  s_lshl_b32 s41, s34, 8
  s_add_u32 s40, s40, s41
  s_lshl_b32 s42, s3, 5
  s_add_u32 s40, s40, s42
  s_add_u32 s44, s41, s42
  v_and_b32 v3, 31, v1
  v_lshrrev_b32 v4, 5, v1
  v_add_u32 v5, s40, v3
  v_mul_u32_u24 v5, 40, v5
  v_lshl_add_u32 v6, v4, 4, v5
  buffer_load_dwordx2 v[8:9], v6, s[8:11], 0 offen
  buffer_load_dwordx2 v[10:11], v6, s[8:11], 0 offen offset:8
  buffer_load_dwordx2 v[12:13], v5, s[8:11], 0 offen offset:32
  s_add_u32 s40, s3, 0
  s_lshl_b32 s41, s40, 10
  s_add_u32 m0, s41, 20480
  s_cmp_lt_u32 s40, 12
  s_cselect_b32 s42, s37, s38
  s_cselect_b32 s43, 0, 12288
  s_add_u32 s42, s42, s41
  s_sub_u32 s42, s42, s43
  buffer_load_dwordx4 v2, s[16:19], s42 offen lds
  s_add_u32 s40, s3, 8
  s_lshl_b32 s41, s40, 10
  s_add_u32 m0, s41, 20480
  s_cmp_lt_u32 s40, 12
  s_cselect_b32 s42, s37, s38
  s_cselect_b32 s43, 0, 12288
  s_add_u32 s42, s42, s41
  s_sub_u32 s42, s42, s43
  buffer_load_dwordx4 v2, s[16:19], s42 offen lds
  s_add_u32 s40, s3, 16
  s_lshl_b32 s41, s40, 10
  s_add_u32 m0, s41, 20480
  s_cmp_lt_u32 s40, 12
  s_cselect_b32 s42, s37, s38
  s_cselect_b32 s43, 0, 12288
  s_add_u32 s42, s42, s41
  s_sub_u32 s42, s42, s43
  buffer_load_dwordx4 v2, s[16:19], s42 offen lds
  v_add_u32 v7, s44, v3
  v_mul_u32_u24 v7, 1280, v7
  s_mul_i32 s45, s33, 40
  v_add_u32 v7, s45, v7
  v_lshl_add_u32 v7, v4, 3, v7
  v_lshlrev_b32 v5, 2, v4
  v_sub_u32 v5, v3, v5
  v_cmp_gt_i32 s[60:61], 0, v5
  v_cmp_gt_i32 s[62:63], 1, v5
  v_cmp_gt_i32 s[64:65], 2, v5
  v_cmp_gt_i32 s[66:67], 3, v5
  v_cmp_gt_i32 s[68:69], 8, v5
  v_cmp_gt_i32 s[70:71], 9, v5
  v_cmp_gt_i32 s[72:73], 10, v5
  v_cmp_gt_i32 s[74:75], 11, v5
  v_cmp_gt_i32 s[76:77], 16, v5
  v_cmp_gt_i32 s[78:79], 17, v5
  v_cmp_gt_i32 s[80:81], 18, v5
  v_cmp_gt_i32 s[82:83], 19, v5
  v_cmp_gt_i32 s[84:85], 24, v5
  v_cmp_gt_i32 s[86:87], 25, v5
  v_cmp_gt_i32 s[88:89], 26, v5
  v_cmp_gt_i32 s[90:91], 27, v5
  v_mov_b32 v248, 0xffff
  v_mov_b32 v249, 0xffff0000
  v_cndmask_b32 v232, 0, v248, s[60:61]
  v_cndmask_b32 v250, 0, v249, s[62:63]
  v_or_b32 v232, v232, v250
  v_cndmask_b32 v233, 0, v248, s[64:65]
  v_cndmask_b32 v250, 0, v249, s[66:67]
  v_or_b32 v233, v233, v250
  v_cndmask_b32 v234, 0, v248, s[68:69]
  v_cndmask_b32 v250, 0, v249, s[70:71]
  v_or_b32 v234, v234, v250
  v_cndmask_b32 v235, 0, v248, s[72:73]
  v_cndmask_b32 v250, 0, v249, s[74:75]
  v_or_b32 v235, v235, v250
  v_cndmask_b32 v236, 0, v248, s[76:77]
  v_cndmask_b32 v250, 0, v249, s[78:79]
  v_or_b32 v236, v236, v250
  v_cndmask_b32 v237, 0, v248, s[80:81]
  v_cndmask_b32 v250, 0, v249, s[82:83]
  v_or_b32 v237, v237, v250
  v_cndmask_b32 v238, 0, v248, s[84:85]
  v_cndmask_b32 v250, 0, v249, s[86:87]
  v_or_b32 v238, v238, v250
  v_cndmask_b32 v239, 0, v248, s[88:89]
  v_cndmask_b32 v250, 0, v249, s[90:91]
  v_or_b32 v239, v239, v250
  s_mul_i32 s46, s3, 1280
  v_mul_u32_u24 v248, 40, v3
  v_add_u32 v248, s46, v248
  v_add_u32 v249, 32, v248
  v_lshl_add_u32 v248, v4, 4, v248
  v_mov_b32 v252, v248
  v_mov_b32 v253, v249
  s_lshl_b32 s46, s3, 5
  v_and_b32 v248, 15, v1
  v_lshrrev_b32 v248, 2, v248
  v_lshl_add_u32 v248, v4, 2, v248
  v_add_u32 v248, s46, v248
  v_mul_u32_u24 v248, 48, v248
  v_lshrrev_b32 v249, 4, v1
  v_and_b32 v249, 1, v249
  v_lshl_add_u32 v248, v249, 5, v248
  v_and_b32 v249, 3, v1
  v_lshl_add_u32 v248, v249, 3, v248
  v_add_u32 v254, 20480, v248
  v_mov_b32 v22, 0
  v_mov_b32 v23, 0
  v_mov_b32 v30, 0
  v_mov_b32 v31, 0
  v_mov_b32 v240, 0x3f803f80
  v_mov_b32 v241, 0x3f80
  v_mov_b32 v242, 0
  v_mov_b32 v243, 0
  v_mov_b32 v246, 0
  v_mov_b32 v247, 0
  v_mov_b32 v14, 0
  v_mov_b32 v15, 0
  v_mov_b32 v32, 0
  v_mov_b32 v33, 0
  v_mov_b32 v34, 0
  v_mov_b32 v35, 0
  v_mov_b32 v36, 0
  v_mov_b32 v37, 0
  v_mov_b32 v38, 0
  v_mov_b32 v39, 0
  v_mov_b32 v40, 0
  v_mov_b32 v41, 0
  v_mov_b32 v42, 0
  v_mov_b32 v43, 0
  v_mov_b32 v44, 0
  v_mov_b32 v45, 0
  v_mov_b32 v46, 0
  v_mov_b32 v47, 0
  s_cmp_eq_u32 s34, 0
  s_cselect_b32 s47, 8, 0
  s_sub_u32 s48, s47, s3
  s_cmp_eq_u32 s34, 0
  s_cselect_b32 s47, s48, 0
  v_cmp_eq_u32 s[58:59], 0, v4
  v_mul_u32_u24 v248, 48, v0
  v_mov_b32 v250, 0x3f80
  v_mov_b32 v251, 0
  s_waitcnt vmcnt(3)
  s_barrier
  s_mov_b32 s26, 2211840
  s_mov_b32 s27, 0x00020000
  s_mov_b32 s30, 2211840
  s_mov_b32 s31, 0x00020000
  s_mov_b32 s54, 2211840
  s_mov_b32 s55, 0x00020000
  s_lshl_b32 s49, s2, 3
  s_add_u32 s49, s49, s3
  s_lshl_b32 s49, s49, 10
  s_add_u32 s50, s49, 0x200000
  s_lshl_b32 s51, s3, 10
  s_add_u32 m0, s51, 45312
  v_lshlrev_b32 v255, 4, v1
  s_mov_b32 s92, s56
  s_mov_b32 s40, s56
  s_mov_b32 s41, s57
  s_mov_b32 s42, 819200
  s_mov_b32 s43, 0x00020000
  s_lshr_b32 s46, s2, 3
  s_lshl_b32 s46, s46, 3
  s_add_u32 s46, s46, s3
  s_lshl_b32 s46, s46, 12
  v_lshlrev_b32 v255, 6, v1
  v_cndmask_b32 v12, 0, v12, s[58:59]
  v_cndmask_b32 v13, 0, v13, s[58:59]
  ds_read_b64 v[20:21], v253 offset:0
  ds_read_b64 v[16:17], v252 offset:0
  ds_read_b64 v[18:19], v252 offset:8
  ds_read_b64 v[28:29], v253 offset:1280
  ds_read_b64 v[24:25], v252 offset:1280
  ds_read_b64 v[26:27], v252 offset:1288
  s_waitcnt lgkmcnt(3)
  s_cmp_gt_u32 s47, 0
  s_cbranch_scc1 p2_fill0
  v_mfma_f32_32x32x16_bf16 v[64:79], v[20:23], v[12:15], 0
  v_mfma_f32_32x32x16_bf16 v[64:79], v[16:19], v[8:11], v[64:79]
p2_back0:
  buffer_load_dword v255, v255, s[40:43], s46 offen
  ds_read_b64 v[20:21], v253 offset:2560
  ds_read_b64 v[16:17], v252 offset:2560
  ds_read_b64 v[18:19], v252 offset:2568
  s_waitcnt lgkmcnt(3)
  s_cmp_gt_u32 s47, 1
  s_cbranch_scc1 p2_fill1
  v_mfma_f32_32x32x16_bf16 v[80:95], v[28:31], v[12:15], 0
  v_mfma_f32_32x32x16_bf16 v[80:95], v[24:27], v[8:11], v[80:95]
p2_back1:
  ds_read_b64 v[28:29], v253 offset:3840
  ds_read_b64 v[24:25], v252 offset:3840
  ds_read_b64 v[26:27], v252 offset:3848
  s_waitcnt lgkmcnt(3)
  s_cmp_gt_u32 s47, 2
  s_cbranch_scc1 p2_fill2
  v_mfma_f32_32x32x16_bf16 v[96:111], v[20:23], v[12:15], 0
  v_mfma_f32_32x32x16_bf16 v[96:111], v[16:19], v[8:11], v[96:111]
p2_back2:
  ds_read_b64 v[20:21], v253 offset:5120
  ds_read_b64 v[16:17], v252 offset:5120
  ds_read_b64 v[18:19], v252 offset:5128
  s_waitcnt lgkmcnt(3)
  s_cmp_gt_u32 s47, 3
  s_cbranch_scc1 p2_fill3
  v_mfma_f32_32x32x16_bf16 v[112:127], v[28:31], v[12:15], 0
  v_mfma_f32_32x32x16_bf16 v[112:127], v[24:27], v[8:11], v[112:127]
p2_back3:
  v_max_f32 v2, v80, v81
  v_max_f32 v5, v82, v83
  v_max_f32 v6, v84, v85
  v_max_f32 v248, v86, v87
  v_max3_f32 v2, v2, v88, v89
  v_max3_f32 v5, v5, v90, v91
  v_max3_f32 v6, v6, v92, v93
  v_max3_f32 v248, v248, v94, v95
  ds_read_b64 v[28:29], v253 offset:6400
  ds_read_b64 v[24:25], v252 offset:6400
  ds_read_b64 v[26:27], v252 offset:6408
  s_waitcnt lgkmcnt(3)
  s_cmp_gt_u32 s47, 4
  s_cbranch_scc1 p2_fill4
  v_mfma_f32_32x32x16_bf16 v[128:143], v[20:23], v[12:15], 0
  v_mfma_f32_32x32x16_bf16 v[128:143], v[16:19], v[8:11], v[128:143]
p2_back4:
  v_max3_f32 v2, v2, v96, v97
  v_max3_f32 v5, v5, v98, v99
  v_max3_f32 v6, v6, v100, v101
  v_max3_f32 v248, v248, v102, v103
  v_max3_f32 v2, v2, v104, v105
  v_max3_f32 v5, v5, v106, v107
  v_max3_f32 v6, v6, v108, v109
  v_max3_f32 v248, v248, v110, v111
  ds_read_b64 v[20:21], v253 offset:7680
  ds_read_b64 v[16:17], v252 offset:7680
  ds_read_b64 v[18:19], v252 offset:7688
  s_waitcnt lgkmcnt(3)
  s_cmp_gt_u32 s47, 5
  s_cbranch_scc1 p2_fill5
  v_mfma_f32_32x32x16_bf16 v[144:159], v[28:31], v[12:15], 0
  v_mfma_f32_32x32x16_bf16 v[144:159], v[24:27], v[8:11], v[144:159]
p2_back5:
  v_max3_f32 v2, v2, v112, v113
  v_max3_f32 v5, v5, v114, v115
  v_max3_f32 v6, v6, v116, v117
  v_max3_f32 v248, v248, v118, v119
  v_max3_f32 v2, v2, v120, v121
  v_max3_f32 v5, v5, v122, v123
  v_max3_f32 v6, v6, v124, v125
  v_max3_f32 v248, v248, v126, v127
  ds_read_b64 v[28:29], v253 offset:8960
  ds_read_b64 v[24:25], v252 offset:8960
  ds_read_b64 v[26:27], v252 offset:8968
  s_waitcnt lgkmcnt(3)
  s_cmp_gt_u32 s47, 6
  s_cbranch_scc1 p2_fill6
  v_mfma_f32_32x32x16_bf16 v[160:175], v[20:23], v[12:15], 0
  v_mfma_f32_32x32x16_bf16 v[160:175], v[16:19], v[8:11], v[160:175]
p2_back6:
  v_max3_f32 v2, v2, v128, v129
  v_max3_f32 v5, v5, v130, v131
  v_max3_f32 v6, v6, v132, v133
  v_max3_f32 v248, v248, v134, v135
  v_max3_f32 v2, v2, v136, v137
  v_max3_f32 v5, v5, v138, v139
  v_max3_f32 v6, v6, v140, v141
  v_max3_f32 v248, v248, v142, v143
  ds_read_b64 v[20:21], v253 offset:10240
  ds_read_b64 v[16:17], v252 offset:10240
  ds_read_b64 v[18:19], v252 offset:10248
  s_waitcnt lgkmcnt(3)
  s_cmp_gt_u32 s47, 7
  s_cbranch_scc1 p2_fill7
  v_mfma_f32_32x32x16_bf16 v[176:191], v[28:31], v[12:15], 0
  v_mfma_f32_32x32x16_bf16 v[176:191], v[24:27], v[8:11], v[176:191]
p2_back7:
  v_max3_f32 v2, v2, v144, v145
  v_max3_f32 v5, v5, v146, v147
  v_max3_f32 v6, v6, v148, v149
  v_max3_f32 v248, v248, v150, v151
  v_max3_f32 v2, v2, v152, v153
  v_max3_f32 v5, v5, v154, v155
  v_max3_f32 v6, v6, v156, v157
  v_max3_f32 v248, v248, v158, v159
  s_waitcnt lgkmcnt(0)
  v_mfma_f32_32x32x16_bf16 v[192:207], v[20:23], v[12:15], 0
  v_mfma_f32_32x32x16_bf16 v[192:207], v[16:19], v[8:11], v[192:207]
  v_max3_f32 v2, v2, v160, v161
  v_max3_f32 v5, v5, v162, v163
  v_max3_f32 v6, v6, v164, v165
  v_max3_f32 v248, v248, v166, v167
  v_max3_f32 v2, v2, v168, v169
  v_max3_f32 v5, v5, v170, v171
  v_max3_f32 v6, v6, v172, v173
  v_max3_f32 v248, v248, v174, v175
  s_waitcnt vmcnt(1)
  s_barrier
  ds_read_b64_tr_b16 v[48:49], v254 offset:0
  ds_read_b64_tr_b16 v[50:51], v254 offset:384
  ds_read_b64_tr_b16 v[52:53], v254 offset:768
  ds_read_b64_tr_b16 v[54:55], v254 offset:1152
  v_max3_f32 v2, v2, v176, v177
  v_max3_f32 v5, v5, v178, v179
  v_max3_f32 v6, v6, v180, v181
  v_max3_f32 v248, v248, v182, v183
  v_max3_f32 v2, v2, v184, v185
  v_max3_f32 v5, v5, v186, v187
  v_max3_f32 v6, v6, v188, v189
  v_max3_f32 v248, v248, v190, v191
  s_nop 3
  v_cndmask_b32 v64, v192, v64, s[60:61]
  v_cndmask_b32 v65, v193, v65, s[62:63]
  v_cndmask_b32 v66, v194, v66, s[64:65]
  v_cndmask_b32 v67, v195, v67, s[66:67]
  v_cndmask_b32 v68, v196, v68, s[68:69]
  v_cndmask_b32 v69, v197, v69, s[70:71]
  v_cndmask_b32 v70, v198, v70, s[72:73]
  v_cndmask_b32 v71, v199, v71, s[74:75]
  v_cndmask_b32 v72, v200, v72, s[76:77]
  v_cndmask_b32 v73, v201, v73, s[78:79]
  v_cndmask_b32 v74, v202, v74, s[80:81]
  v_cndmask_b32 v75, v203, v75, s[82:83]
  v_cndmask_b32 v76, v204, v76, s[84:85]
  v_cndmask_b32 v77, v205, v77, s[86:87]
  v_cndmask_b32 v78, v206, v78, s[88:89]
  v_cndmask_b32 v79, v207, v79, s[90:91]
  v_max3_f32 v2, v2, v64, v65
  v_max3_f32 v5, v5, v66, v67
  v_max3_f32 v6, v6, v68, v69
  v_max3_f32 v248, v248, v70, v71
  v_max3_f32 v2, v2, v72, v73
  v_max3_f32 v5, v5, v74, v75
  v_max3_f32 v6, v6, v76, v77
  v_max3_f32 v248, v248, v78, v79
  v_max3_f32 v2, v2, v5, v6
  v_max_f32 v2, v2, v248
  v_mov_b32 v5, v2
  s_nop 1
  v_permlane32_swap_b32 v2, v5
  s_nop 1
  v_max_f32 v2, v2, v5
  v_sub_f32 v2, 0, v2
  v_and_b32 v5, 0xffff0000, v2
  v_sub_f32 v2, v2, v5
  v_and_b32 v6, 0xffff0000, v2
  v_sub_f32 v2, v2, v6
  v_lshrrev_b32 v5, 16, v5
  v_or_b32 v5, v5, v6
  v_lshrrev_b32 v2, 16, v2
  v_cndmask_b32 v244, 0, v5, s[58:59]
  v_cndmask_b32 v245, 0, v2, s[58:59]
  s_nop 1
  v_mfma_f32_32x32x16_bf16 v[64:79], v[240:243], v[244:247], v[64:79]
  v_mfma_f32_32x32x16_bf16 v[80:95], v[240:243], v[244:247], v[80:95]
  s_nop 7
  v_mfma_f32_32x32x16_bf16 v[96:111], v[240:243], v[244:247], v[96:111]
  ds_read_b64_tr_b16 v[56:57], v254 offset:12288
  ds_read_b64_tr_b16 v[58:59], v254 offset:12672
  ds_read_b64_tr_b16 v[60:61], v254 offset:13056
  ds_read_b64_tr_b16 v[62:63], v254 offset:13440
  v_exp_f32 v64, v64
  v_exp_f32 v65, v65
  v_exp_f32 v66, v66
  v_exp_f32 v67, v67
  v_exp_f32 v68, v68
  v_exp_f32 v69, v69
  v_exp_f32 v70, v70
  v_exp_f32 v71, v71
  v_exp_f32 v72, v72
  v_exp_f32 v73, v73
  v_exp_f32 v74, v74
  v_exp_f32 v75, v75
  v_exp_f32 v76, v76
  v_exp_f32 v77, v77
  v_exp_f32 v78, v78
  v_exp_f32 v79, v79
  s_nop 0
  v_cvt_pk_bf16_f32 v208, v64, v65
  v_cvt_pk_bf16_f32 v209, v66, v67
  v_cvt_pk_bf16_f32 v210, v68, v69
  v_cvt_pk_bf16_f32 v211, v70, v71
  v_cvt_pk_bf16_f32 v212, v72, v73
  v_cvt_pk_bf16_f32 v213, v74, v75
  v_cvt_pk_bf16_f32 v214, v76, v77
  v_cvt_pk_bf16_f32 v215, v78, v79
  v_bfi_b32 v224, v232, 0, v208
  v_bfi_b32 v225, v233, 0, v209
  v_bfi_b32 v226, v234, 0, v210
  v_bfi_b32 v227, v235, 0, v211
  v_bfi_b32 v228, v236, 0, v212
  v_bfi_b32 v229, v237, 0, v213
  v_bfi_b32 v230, v238, 0, v214
  v_bfi_b32 v231, v239, 0, v215
  v_and_b32 v208, v232, v208
  v_and_b32 v209, v233, v209
  v_and_b32 v210, v234, v210
  v_and_b32 v211, v235, v211
  v_and_b32 v212, v236, v212
  v_and_b32 v213, v237, v213
  v_and_b32 v214, v238, v214
  v_and_b32 v215, v239, v215
  s_waitcnt lgkmcnt(4)
  v_mfma_f32_32x32x16_bf16 v[32:47], v[48:51], v[208:211], v[32:47]
  v_mfma_f32_32x32x16_bf16 v[32:47], v[52:55], v[212:215], v[32:47]
  ds_read_b64_tr_b16 v[48:49], v254 offset:1536
  ds_read_b64_tr_b16 v[50:51], v254 offset:1920
  ds_read_b64_tr_b16 v[52:53], v254 offset:2304
  ds_read_b64_tr_b16 v[54:55], v254 offset:2688
  s_waitcnt lgkmcnt(4)
  v_mfma_f32_32x32x16_bf16 v[32:47], v[56:59], v[224:227], v[32:47]
  v_mfma_f32_32x32x16_bf16 v[32:47], v[60:63], v[228:231], v[32:47]
  v_mfma_f32_32x32x16_bf16 v[112:127], v[240:243], v[244:247], v[112:127]
  ds_read_b64_tr_b16 v[56:57], v254 offset:3072
  ds_read_b64_tr_b16 v[58:59], v254 offset:3456
  ds_read_b64_tr_b16 v[60:61], v254 offset:3840
  ds_read_b64_tr_b16 v[62:63], v254 offset:4224
  v_exp_f32 v80, v80
  v_exp_f32 v81, v81
  v_exp_f32 v82, v82
  v_exp_f32 v83, v83
  v_exp_f32 v84, v84
  v_exp_f32 v85, v85
  v_exp_f32 v86, v86
  v_exp_f32 v87, v87
  v_exp_f32 v88, v88
  v_exp_f32 v89, v89
  v_exp_f32 v90, v90
  v_exp_f32 v91, v91
  v_exp_f32 v92, v92
  v_exp_f32 v93, v93
  v_exp_f32 v94, v94
  v_exp_f32 v95, v95
  s_nop 0
  v_cvt_pk_bf16_f32 v216, v80, v81
  v_cvt_pk_bf16_f32 v217, v82, v83
  v_cvt_pk_bf16_f32 v218, v84, v85
  v_cvt_pk_bf16_f32 v219, v86, v87
  v_cvt_pk_bf16_f32 v220, v88, v89
  v_cvt_pk_bf16_f32 v221, v90, v91
  v_cvt_pk_bf16_f32 v222, v92, v93
  v_cvt_pk_bf16_f32 v223, v94, v95
  s_nop 0
  s_waitcnt lgkmcnt(4)
  v_mfma_f32_32x32x16_bf16 v[32:47], v[48:51], v[216:219], v[32:47]
  v_mfma_f32_32x32x16_bf16 v[32:47], v[52:55], v[220:223], v[32:47]
  v_mfma_f32_32x32x16_bf16 v[128:143], v[240:243], v[244:247], v[128:143]
  ds_read_b64_tr_b16 v[48:49], v254 offset:4608
  ds_read_b64_tr_b16 v[50:51], v254 offset:4992
  ds_read_b64_tr_b16 v[52:53], v254 offset:5376
  ds_read_b64_tr_b16 v[54:55], v254 offset:5760
  v_exp_f32 v96, v96
  v_exp_f32 v97, v97
  v_exp_f32 v98, v98
  v_exp_f32 v99, v99
  v_exp_f32 v100, v100
  v_exp_f32 v101, v101
  v_exp_f32 v102, v102
  v_exp_f32 v103, v103
  v_exp_f32 v104, v104
  v_exp_f32 v105, v105
  v_exp_f32 v106, v106
  v_exp_f32 v107, v107
  v_exp_f32 v108, v108
  v_exp_f32 v109, v109
  v_exp_f32 v110, v110
  v_exp_f32 v111, v111
  s_nop 0
  v_cvt_pk_bf16_f32 v208, v96, v97
  v_cvt_pk_bf16_f32 v209, v98, v99
  v_cvt_pk_bf16_f32 v210, v100, v101
  v_cvt_pk_bf16_f32 v211, v102, v103
  v_cvt_pk_bf16_f32 v212, v104, v105
  v_cvt_pk_bf16_f32 v213, v106, v107
  v_cvt_pk_bf16_f32 v214, v108, v109
  v_cvt_pk_bf16_f32 v215, v110, v111
  s_nop 0
  s_waitcnt lgkmcnt(4)
  v_mfma_f32_32x32x16_bf16 v[32:47], v[56:59], v[208:211], v[32:47]
  v_mfma_f32_32x32x16_bf16 v[32:47], v[60:63], v[212:215], v[32:47]
  v_mfma_f32_32x32x16_bf16 v[144:159], v[240:243], v[244:247], v[144:159]
  ds_read_b64_tr_b16 v[56:57], v254 offset:6144
  ds_read_b64_tr_b16 v[58:59], v254 offset:6528
  ds_read_b64_tr_b16 v[60:61], v254 offset:6912
  ds_read_b64_tr_b16 v[62:63], v254 offset:7296
  v_exp_f32 v112, v112
  v_exp_f32 v113, v113
  v_exp_f32 v114, v114
  v_exp_f32 v115, v115
  v_exp_f32 v116, v116
  v_exp_f32 v117, v117
  v_exp_f32 v118, v118
  v_exp_f32 v119, v119
  v_exp_f32 v120, v120
  v_exp_f32 v121, v121
  v_exp_f32 v122, v122
  v_exp_f32 v123, v123
  v_exp_f32 v124, v124
  v_exp_f32 v125, v125
  v_exp_f32 v126, v126
  v_exp_f32 v127, v127
  s_nop 0
  v_cvt_pk_bf16_f32 v216, v112, v113
  v_cvt_pk_bf16_f32 v217, v114, v115
  v_cvt_pk_bf16_f32 v218, v116, v117
  v_cvt_pk_bf16_f32 v219, v118, v119
  v_cvt_pk_bf16_f32 v220, v120, v121
  v_cvt_pk_bf16_f32 v221, v122, v123
  v_cvt_pk_bf16_f32 v222, v124, v125
  v_cvt_pk_bf16_f32 v223, v126, v127
  s_nop 0
  s_waitcnt lgkmcnt(4)
  v_mfma_f32_32x32x16_bf16 v[32:47], v[48:51], v[216:219], v[32:47]
  v_mfma_f32_32x32x16_bf16 v[32:47], v[52:55], v[220:223], v[32:47]
  v_mfma_f32_32x32x16_bf16 v[160:175], v[240:243], v[244:247], v[160:175]
  ds_read_b64_tr_b16 v[48:49], v254 offset:7680
  ds_read_b64_tr_b16 v[50:51], v254 offset:8064
  ds_read_b64_tr_b16 v[52:53], v254 offset:8448
  ds_read_b64_tr_b16 v[54:55], v254 offset:8832
  v_exp_f32 v128, v128
  v_exp_f32 v129, v129
  v_exp_f32 v130, v130
  v_exp_f32 v131, v131
  v_exp_f32 v132, v132
  v_exp_f32 v133, v133
  v_exp_f32 v134, v134
  v_exp_f32 v135, v135
  v_exp_f32 v136, v136
  v_exp_f32 v137, v137
  v_exp_f32 v138, v138
  v_exp_f32 v139, v139
  v_exp_f32 v140, v140
  v_exp_f32 v141, v141
  v_exp_f32 v142, v142
  v_exp_f32 v143, v143
  s_nop 0
  v_cvt_pk_bf16_f32 v208, v128, v129
  v_cvt_pk_bf16_f32 v209, v130, v131
  v_cvt_pk_bf16_f32 v210, v132, v133
  v_cvt_pk_bf16_f32 v211, v134, v135
  v_cvt_pk_bf16_f32 v212, v136, v137
  v_cvt_pk_bf16_f32 v213, v138, v139
  v_cvt_pk_bf16_f32 v214, v140, v141
  v_cvt_pk_bf16_f32 v215, v142, v143
  s_nop 0
  s_waitcnt lgkmcnt(4)
  v_mfma_f32_32x32x16_bf16 v[32:47], v[56:59], v[208:211], v[32:47]
  v_mfma_f32_32x32x16_bf16 v[32:47], v[60:63], v[212:215], v[32:47]
  v_mfma_f32_32x32x16_bf16 v[176:191], v[240:243], v[244:247], v[176:191]
  ds_read_b64_tr_b16 v[56:57], v254 offset:9216
  ds_read_b64_tr_b16 v[58:59], v254 offset:9600
  ds_read_b64_tr_b16 v[60:61], v254 offset:9984
  ds_read_b64_tr_b16 v[62:63], v254 offset:10368
  v_exp_f32 v144, v144
  v_exp_f32 v145, v145
  v_exp_f32 v146, v146
  v_exp_f32 v147, v147
  v_exp_f32 v148, v148
  v_exp_f32 v149, v149
  v_exp_f32 v150, v150
  v_exp_f32 v151, v151
  v_exp_f32 v152, v152
  v_exp_f32 v153, v153
  v_exp_f32 v154, v154
  v_exp_f32 v155, v155
  v_exp_f32 v156, v156
  v_exp_f32 v157, v157
  v_exp_f32 v158, v158
  v_exp_f32 v159, v159
  s_nop 0
  v_cvt_pk_bf16_f32 v216, v144, v145
  v_cvt_pk_bf16_f32 v217, v146, v147
  v_cvt_pk_bf16_f32 v218, v148, v149
  v_cvt_pk_bf16_f32 v219, v150, v151
  v_cvt_pk_bf16_f32 v220, v152, v153
  v_cvt_pk_bf16_f32 v221, v154, v155
  v_cvt_pk_bf16_f32 v222, v156, v157
  v_cvt_pk_bf16_f32 v223, v158, v159
  s_nop 0
  s_waitcnt lgkmcnt(4)
  v_mfma_f32_32x32x16_bf16 v[32:47], v[48:51], v[216:219], v[32:47]
  v_mfma_f32_32x32x16_bf16 v[32:47], v[52:55], v[220:223], v[32:47]
  ds_read_b64_tr_b16 v[48:49], v254 offset:10752
  ds_read_b64_tr_b16 v[50:51], v254 offset:11136
  ds_read_b64_tr_b16 v[52:53], v254 offset:11520
  ds_read_b64_tr_b16 v[54:55], v254 offset:11904
  v_exp_f32 v160, v160
  v_exp_f32 v161, v161
  v_exp_f32 v162, v162
  v_exp_f32 v163, v163
  v_exp_f32 v164, v164
  v_exp_f32 v165, v165
  v_exp_f32 v166, v166
  v_exp_f32 v167, v167
  v_exp_f32 v168, v168
  v_exp_f32 v169, v169
  v_exp_f32 v170, v170
  v_exp_f32 v171, v171
  v_exp_f32 v172, v172
  v_exp_f32 v173, v173
  v_exp_f32 v174, v174
  v_exp_f32 v175, v175
  s_nop 0
  v_cvt_pk_bf16_f32 v208, v160, v161
  v_cvt_pk_bf16_f32 v209, v162, v163
  v_cvt_pk_bf16_f32 v210, v164, v165
  v_cvt_pk_bf16_f32 v211, v166, v167
  v_cvt_pk_bf16_f32 v212, v168, v169
  v_cvt_pk_bf16_f32 v213, v170, v171
  v_cvt_pk_bf16_f32 v214, v172, v173
  v_cvt_pk_bf16_f32 v215, v174, v175
  s_nop 0
  s_waitcnt lgkmcnt(4)
  v_mfma_f32_32x32x16_bf16 v[32:47], v[56:59], v[208:211], v[32:47]
  v_mfma_f32_32x32x16_bf16 v[32:47], v[60:63], v[212:215], v[32:47]
  v_exp_f32 v176, v176
  v_exp_f32 v177, v177
  v_exp_f32 v178, v178
  v_exp_f32 v179, v179
  v_exp_f32 v180, v180
  v_exp_f32 v181, v181
  v_exp_f32 v182, v182
  v_exp_f32 v183, v183
  v_exp_f32 v184, v184
  v_exp_f32 v185, v185
  v_exp_f32 v186, v186
  v_exp_f32 v187, v187
  v_exp_f32 v188, v188
  v_exp_f32 v189, v189
  v_exp_f32 v190, v190
  v_exp_f32 v191, v191
  s_nop 0
  v_cvt_pk_bf16_f32 v216, v176, v177
  v_cvt_pk_bf16_f32 v217, v178, v179
  v_cvt_pk_bf16_f32 v218, v180, v181
  v_cvt_pk_bf16_f32 v219, v182, v183
  v_cvt_pk_bf16_f32 v220, v184, v185
  v_cvt_pk_bf16_f32 v221, v186, v187
  v_cvt_pk_bf16_f32 v222, v188, v189
  v_cvt_pk_bf16_f32 v223, v190, v191
  s_nop 0
  s_waitcnt lgkmcnt(0)
  v_mfma_f32_32x32x16_bf16 v[32:47], v[48:51], v[216:219], v[32:47]
  v_mfma_f32_32x32x16_bf16 v[32:47], v[52:55], v[220:223], v[32:47]
  s_nop 15
  v_mov_b32 v2, v40
  v_mov_b32 v5, v40
  s_nop 1
  v_permlane32_swap_b32 v2, v5
  s_nop 1
  v_rcp_f32 v5, v5
  s_nop 0
  v_mul_f32 v32, v32, v5
  v_mul_f32 v33, v33, v5
  v_mul_f32 v34, v34, v5
  v_mul_f32 v35, v35, v5
  v_mul_f32 v36, v36, v5
  v_mul_f32 v37, v37, v5
  v_mul_f32 v38, v38, v5
  v_mul_f32 v39, v39, v5
  v_mul_f32 v40, v40, v5
  v_mul_f32 v41, v41, v5
  v_mul_f32 v42, v42, v5
  v_mul_f32 v43, v43, v5
  v_cvt_pk_bf16_f32 v48, v32, v33
  v_cvt_pk_bf16_f32 v49, v34, v35
  v_cvt_pk_bf16_f32 v50, v36, v37
  v_cvt_pk_bf16_f32 v51, v38, v39
  v_cvt_pk_bf16_f32 v52, v40, v41
  v_cvt_pk_bf16_f32 v53, v42, v43
  buffer_store_dwordx2 v[48:49], v7, s[20:23], 0 offen
  buffer_store_dwordx2 v[50:51], v7, s[20:23], 0 offen offset:16
  s_mov_b64 exec, s[58:59]
  buffer_store_dwordx2 v[52:53], v7, s[20:23], 0 offen offset:32
  s_mov_b64 exec, -1
  s_waitcnt vmcnt(0)
  s_endpgm
p2_fill0:
  v_mov_b32 v64, 0xff800000
  v_mov_b32 v65, 0xff800000
  v_mov_b32 v66, 0xff800000
  v_mov_b32 v67, 0xff800000
  v_mov_b32 v68, 0xff800000
  v_mov_b32 v69, 0xff800000
  v_mov_b32 v70, 0xff800000
  v_mov_b32 v71, 0xff800000
  v_mov_b32 v72, 0xff800000
  v_mov_b32 v73, 0xff800000
  v_mov_b32 v74, 0xff800000
  v_mov_b32 v75, 0xff800000
  v_mov_b32 v76, 0xff800000
  v_mov_b32 v77, 0xff800000
  v_mov_b32 v78, 0xff800000
  v_mov_b32 v79, 0xff800000
  s_branch p2_back0
p2_fill1:
  v_mov_b32 v80, 0xff800000
  v_mov_b32 v81, 0xff800000
  v_mov_b32 v82, 0xff800000
  v_mov_b32 v83, 0xff800000
  v_mov_b32 v84, 0xff800000
  v_mov_b32 v85, 0xff800000
  v_mov_b32 v86, 0xff800000
  v_mov_b32 v87, 0xff800000
  v_mov_b32 v88, 0xff800000
  v_mov_b32 v89, 0xff800000
  v_mov_b32 v90, 0xff800000
  v_mov_b32 v91, 0xff800000
  v_mov_b32 v92, 0xff800000
  v_mov_b32 v93, 0xff800000
  v_mov_b32 v94, 0xff800000
  v_mov_b32 v95, 0xff800000
  s_branch p2_back1
p2_fill2:
  v_mov_b32 v96, 0xff800000
  v_mov_b32 v97, 0xff800000
  v_mov_b32 v98, 0xff800000
  v_mov_b32 v99, 0xff800000
  v_mov_b32 v100, 0xff800000
  v_mov_b32 v101, 0xff800000
  v_mov_b32 v102, 0xff800000
  v_mov_b32 v103, 0xff800000
  v_mov_b32 v104, 0xff800000
  v_mov_b32 v105, 0xff800000
  v_mov_b32 v106, 0xff800000
  v_mov_b32 v107, 0xff800000
  v_mov_b32 v108, 0xff800000
  v_mov_b32 v109, 0xff800000
  v_mov_b32 v110, 0xff800000
  v_mov_b32 v111, 0xff800000
  s_branch p2_back2
p2_fill3:
  v_mov_b32 v112, 0xff800000
  v_mov_b32 v113, 0xff800000
  v_mov_b32 v114, 0xff800000
  v_mov_b32 v115, 0xff800000
  v_mov_b32 v116, 0xff800000
  v_mov_b32 v117, 0xff800000
  v_mov_b32 v118, 0xff800000
  v_mov_b32 v119, 0xff800000
  v_mov_b32 v120, 0xff800000
  v_mov_b32 v121, 0xff800000
  v_mov_b32 v122, 0xff800000
  v_mov_b32 v123, 0xff800000
  v_mov_b32 v124, 0xff800000
  v_mov_b32 v125, 0xff800000
  v_mov_b32 v126, 0xff800000
  v_mov_b32 v127, 0xff800000
  s_branch p2_back3
p2_fill4:
  v_mov_b32 v128, 0xff800000
  v_mov_b32 v129, 0xff800000
  v_mov_b32 v130, 0xff800000
  v_mov_b32 v131, 0xff800000
  v_mov_b32 v132, 0xff800000
  v_mov_b32 v133, 0xff800000
  v_mov_b32 v134, 0xff800000
  v_mov_b32 v135, 0xff800000
  v_mov_b32 v136, 0xff800000
  v_mov_b32 v137, 0xff800000
  v_mov_b32 v138, 0xff800000
  v_mov_b32 v139, 0xff800000
  v_mov_b32 v140, 0xff800000
  v_mov_b32 v141, 0xff800000
  v_mov_b32 v142, 0xff800000
  v_mov_b32 v143, 0xff800000
  s_branch p2_back4
p2_fill5:
  v_mov_b32 v144, 0xff800000
  v_mov_b32 v145, 0xff800000
  v_mov_b32 v146, 0xff800000
  v_mov_b32 v147, 0xff800000
  v_mov_b32 v148, 0xff800000
  v_mov_b32 v149, 0xff800000
  v_mov_b32 v150, 0xff800000
  v_mov_b32 v151, 0xff800000
  v_mov_b32 v152, 0xff800000
  v_mov_b32 v153, 0xff800000
  v_mov_b32 v154, 0xff800000
  v_mov_b32 v155, 0xff800000
  v_mov_b32 v156, 0xff800000
  v_mov_b32 v157, 0xff800000
  v_mov_b32 v158, 0xff800000
  v_mov_b32 v159, 0xff800000
  s_branch p2_back5
p2_fill6:
  v_mov_b32 v160, 0xff800000
  v_mov_b32 v161, 0xff800000
  v_mov_b32 v162, 0xff800000
  v_mov_b32 v163, 0xff800000
  v_mov_b32 v164, 0xff800000
  v_mov_b32 v165, 0xff800000
  v_mov_b32 v166, 0xff800000
  v_mov_b32 v167, 0xff800000
  v_mov_b32 v168, 0xff800000
  v_mov_b32 v169, 0xff800000
  v_mov_b32 v170, 0xff800000
  v_mov_b32 v171, 0xff800000
  v_mov_b32 v172, 0xff800000
  v_mov_b32 v173, 0xff800000
  v_mov_b32 v174, 0xff800000
  v_mov_b32 v175, 0xff800000
  s_branch p2_back6
p2_fill7:
  v_mov_b32 v176, 0xff800000
  v_mov_b32 v177, 0xff800000
  v_mov_b32 v178, 0xff800000
  v_mov_b32 v179, 0xff800000
  v_mov_b32 v180, 0xff800000
  v_mov_b32 v181, 0xff800000
  v_mov_b32 v182, 0xff800000
  v_mov_b32 v183, 0xff800000
  v_mov_b32 v184, 0xff800000
  v_mov_b32 v185, 0xff800000
  v_mov_b32 v186, 0xff800000
  v_mov_b32 v187, 0xff800000
  v_mov_b32 v188, 0xff800000
  v_mov_b32 v189, 0xff800000
  v_mov_b32 v190, 0xff800000
  v_mov_b32 v191, 0xff800000
  s_branch p2_back7
p2_END:
  s_endpgm
.section .rodata,"a"
.p2align 6
.amdhsa_kernel p2_kernel
  .amdhsa_next_free_vgpr 256
  .amdhsa_next_free_sgpr 102
  .amdhsa_accum_offset 256
  .amdhsa_group_segment_fixed_size 0
  .amdhsa_kernarg_size 96
  .amdhsa_user_sgpr_count 2
  .amdhsa_user_sgpr_kernarg_segment_ptr 1
  .amdhsa_system_sgpr_workgroup_id_x 1
.end_amdhsa_kernel
.text
.globl p3_kernel
.p2align 8
.type p3_kernel,@function
p3_kernel:
  s_cmp_ge_u32 s2, 251
  s_cbranch_scc1 p3_END
  s_load_dwordx2 s[4:5], s[0:1], 16
  s_load_dwordx2 s[6:7], s[0:1], 88
  s_load_dwordx2 s[24:25], s[0:1], 0
  s_load_dwordx2 s[26:27], s[0:1], 32
  s_load_dwordx2 s[28:29], s[0:1], 40
  v_lshrrev_b32 v1, 6, v0
  s_nop 0
  v_readfirstlane_b32 s3, v1
  v_and_b32 v1, 63, v0
  s_nop 3
  s_cmp_ge_u32 s2, 224
  s_cbranch_scc1 p3_special
  s_and_b32 s33, s2, 7
  s_mul_i32 s33, s33, 28
  s_lshr_b32 s34, s2, 3
  s_cmp_ge_u32 s34, 28
  s_cbranch_scc1 p3_END
  s_add_u32 s33, s33, s34
  s_cmp_ge_u32 s33, 220
  s_cbranch_scc1 p3_END
  s_mul_i32 s34, s33, 6554
  s_lshr_b32 s34, s34, 16
  s_mul_i32 s35, s34, 10
  s_sub_u32 s61, s33, s35
  s_mul_i32 s34, s34, 96
  s_min_u32 s60, s34, 1952
  s_lshl_b32 s37, s61, 7
  s_cmp_lt_u32 s3, 3
  s_cbranch_scc1 p3_comp
  s_mul_i32 s36, s60, 1280
  s_sub_u32 s43, s3, 3
  v_lshrrev_b32 v2, 3, v1
  s_lshl_b32 s47, s43, 3
  v_add_u32 v2, s47, v2
  v_lshrrev_b32 v3, 1, v2
  v_and_b32 v3, 7, v3
  v_and_b32 v4, 7, v1
  v_xor_b32 v3, v3, v4
  v_lshlrev_b32 v3, 4, v3
  s_mov_b32 s47, 1280
  v_mad_u32_u24 v2, v2, s47, v3
  v_add_u32 v8, s36, v2
  v_add_u32 v9, 40960, v8
  v_add_u32 v10, 81920, v8
  v_lshrrev_b32 v2, 3, v1
  s_lshl_b32 s47, s43, 3
  v_add_u32 v2, s47, v2
  v_lshrrev_b32 v3, 4, v1
  v_and_b32 v3, 1, v3
  v_lshlrev_b32 v3, 2, v3
  v_and_b32 v4, 7, v1
  v_xor_b32 v3, v3, v4
  v_lshlrev_b32 v3, 4, v3
  s_mov_b32 s47, 1280
  v_mad_u32_u24 v2, v2, s47, v3
  v_add_u32 v11, s37, v2
  v_add_u32 v12, 40960, v11
  s_lshl_b32 s40, s43, 10
  s_mov_b32 s41, 0
  s_mov_b32 s42, 0
  s_mov_b32 s45, 0
  s_mov_b32 s44, 0
  s_waitcnt lgkmcnt(0)
  s_add_u32 s8, s6, 0xe00000
  s_addc_u32 s9, s7, 0
  s_mov_b32 s10, 0x280000
  s_mov_b32 s11, 0x00020000
  s_mov_b32 s12, s4
  s_mov_b32 s13, s5
  s_mov_b32 s14, 0xc8000
  s_mov_b32 s15, 0x00020000
  s_add_u32 s47, s40, 0
  s_add_u32 m0, s47, 0
  s_nop 0
  buffer_load_dwordx4 v8, s[8:11], s41 offen lds
  s_add_u32 m0, s47, 4096
  s_nop 0
  buffer_load_dwordx4 v9, s[8:11], s41 offen lds
  s_add_u32 m0, s47, 8192
  s_nop 0
  buffer_load_dwordx4 v10, s[8:11], s41 offen lds
  s_add_u32 m0, s47, 12288
  s_nop 0
  buffer_load_dwordx4 v11, s[12:15], s42 offen lds
  s_add_u32 m0, s47, 16384
  s_nop 0
  buffer_load_dwordx4 v12, s[12:15], s42 offen lds
  s_add_u32 s41, s41, 128
  s_add_u32 s42, s42, 81920
  s_add_u32 s47, s40, 20480
  s_add_u32 m0, s47, 0
  s_nop 0
  buffer_load_dwordx4 v8, s[8:11], s41 offen lds
  s_add_u32 m0, s47, 4096
  s_nop 0
  buffer_load_dwordx4 v9, s[8:11], s41 offen lds
  s_add_u32 m0, s47, 8192
  s_nop 0
  buffer_load_dwordx4 v10, s[8:11], s41 offen lds
  s_add_u32 m0, s47, 12288
  s_nop 0
  buffer_load_dwordx4 v11, s[12:15], s42 offen lds
  s_add_u32 m0, s47, 16384
  s_nop 0
  buffer_load_dwordx4 v12, s[12:15], s42 offen lds
  s_add_u32 s41, s41, 128
  s_add_u32 s42, s42, 81920
  s_add_u32 s47, s40, 40960
  s_add_u32 m0, s47, 0
  s_nop 0
  buffer_load_dwordx4 v8, s[8:11], s41 offen lds
  s_add_u32 m0, s47, 4096
  s_nop 0
  buffer_load_dwordx4 v9, s[8:11], s41 offen lds
  s_add_u32 m0, s47, 8192
  s_nop 0
  buffer_load_dwordx4 v10, s[8:11], s41 offen lds
  s_add_u32 m0, s47, 12288
  s_nop 0
  buffer_load_dwordx4 v11, s[12:15], s42 offen lds
  s_add_u32 m0, s47, 16384
  s_nop 0
  buffer_load_dwordx4 v12, s[12:15], s42 offen lds
  s_add_u32 s41, s41, 128
  s_add_u32 s42, s42, 81920
  s_waitcnt vmcnt(10)
  s_barrier
  s_add_u32 s47, s40, 61440
  s_add_u32 m0, s47, 0
  s_nop 0
  buffer_load_dwordx4 v8, s[8:11], s41 offen lds
  s_add_u32 m0, s47, 4096
  s_nop 0
  buffer_load_dwordx4 v9, s[8:11], s41 offen lds
  s_add_u32 m0, s47, 8192
  s_nop 0
  buffer_load_dwordx4 v10, s[8:11], s41 offen lds
  s_add_u32 m0, s47, 12288
  s_nop 0
  buffer_load_dwordx4 v11, s[12:15], s42 offen lds
  s_add_u32 m0, s47, 16384
  s_nop 0
  buffer_load_dwordx4 v12, s[12:15], s42 offen lds
  s_add_u32 s41, s41, 128
  s_add_u32 s42, s42, 81920
  s_mov_b32 s45, 81920
p3_ll_1:
  s_waitcnt vmcnt(10)
  s_barrier
  s_add_u32 s47, s40, s45
  s_add_u32 m0, s47, 0
  s_nop 0
  buffer_load_dwordx4 v8, s[8:11], s41 offen lds
  s_add_u32 m0, s47, 4096
  s_nop 0
  buffer_load_dwordx4 v9, s[8:11], s41 offen lds
  s_add_u32 m0, s47, 8192
  s_nop 0
  buffer_load_dwordx4 v10, s[8:11], s41 offen lds
  s_add_u32 m0, s47, 12288
  s_nop 0
  buffer_load_dwordx4 v11, s[12:15], s42 offen lds
  s_add_u32 m0, s47, 16384
  s_nop 0
  buffer_load_dwordx4 v12, s[12:15], s42 offen lds
  s_add_u32 s41, s41, 128
  s_add_u32 s42, s42, 81920
  s_add_u32 s45, s45, 20480
  s_cmp_eq_u32 s45, 102400
  s_cselect_b32 s45, 0, s45
  s_add_u32 s44, s44, 1
  s_cmp_lt_u32 s44, 6
  s_cbranch_scc1 p3_ll_1
  s_waitcnt vmcnt(10)
  s_barrier
  s_waitcnt vmcnt(5)
  s_barrier
  s_waitcnt vmcnt(0)
  s_barrier
  s_endpgm
p3_comp:
  s_lshl_b32 s47, s3, 5
  s_add_u32 s47, s47, s60
  v_lshrrev_b32 v2, 3, v1
  v_add_u32 v2, s47, v2
  s_movk_i32 s47, 1280
  v_mul_lo_u32 v2, v2, s47
  v_lshrrev_b32 v3, 4, v1
  v_xor_b32 v3, v3, v1
  v_and_b32 v3, 7, v3
  v_lshl_add_u32 v2, v3, 4, v2
  v_add_u32 v179, s37, v2
  v_xor_b32 v180, 64, v179
  v_lshrrev_b32 v3, 5, v1
  v_lshlrev_b32 v177, 4, v3
  s_lshl_b32 s38, s61, 8
  v_add_u32 v177, s38, v177
  s_lshl_b32 s59, s3, 5
  s_add_u32 s59, s59, s60
  v_and_b32 v2, 31, v1
  v_add_u32 v2, s59, v2
  v_mul_u32_u24 v178, 160, v2
  s_lshl_b32 s38, s61, 4
  v_add_u32 v178, s38, v178
  v_lshl_add_u32 v178, v3, 3, v178
  v_and_b32 v2, 31, v1
  s_lshl_b32 s47, s3, 5
  v_add_u32 v2, s47, v2
  v_lshrrev_b32 v3, 1, v2
  v_and_b32 v3, 7, v3
  v_lshrrev_b32 v4, 5, v1
  v_xor_b32 v3, v3, v4
  v_lshlrev_b32 v3, 4, v3
  v_lshl_add_u32 v88, v2, 7, v3
  v_xor_b32 v89, 32, v88
  v_xor_b32 v90, 64, v88
  v_xor_b32 v91, 96, v88
  v_lshlrev_b32 v2, 3, v4
  v_and_b32 v3, 15, v1
  v_lshrrev_b32 v3, 2, v3
  v_add_u32 v2, v2, v3
  v_mul_u32_u24 v2, 128, v2
  v_lshrrev_b32 v3, 4, v1
  v_and_b32 v3, 1, v3
  v_lshl_add_u32 v2, v3, 5, v2
  v_and_b32 v3, 3, v1
  v_lshl_add_u32 v2, v3, 3, v2
  v_lshrrev_b32 v3, 3, v1
  v_and_b32 v3, 1, v3
  v_lshl_add_u32 v2, v3, 6, v2
  v_add_u32 v92, 12288, v2
  v_xor_b32 v93, 64, v92
  s_mov_b32 s45, 0
  s_mov_b32 s44, 0
  v_mov_b32 v8, 0
  v_mov_b32 v9, 0
  v_mov_b32 v10, 0
  v_mov_b32 v11, 0
  v_mov_b32 v12, 0
  v_mov_b32 v13, 0
  v_mov_b32 v14, 0
  v_mov_b32 v15, 0
  v_mov_b32 v16, 0
  v_mov_b32 v17, 0
  v_mov_b32 v18, 0
  v_mov_b32 v19, 0
  v_mov_b32 v20, 0
  v_mov_b32 v21, 0
  v_mov_b32 v22, 0
  v_mov_b32 v23, 0
  v_mov_b32 v24, 0
  v_mov_b32 v25, 0
  v_mov_b32 v26, 0
  v_mov_b32 v27, 0
  v_mov_b32 v28, 0
  v_mov_b32 v29, 0
  v_mov_b32 v30, 0
  v_mov_b32 v31, 0
  v_mov_b32 v32, 0
  v_mov_b32 v33, 0
  v_mov_b32 v34, 0
  v_mov_b32 v35, 0
  v_mov_b32 v36, 0
  v_mov_b32 v37, 0
  v_mov_b32 v38, 0
  v_mov_b32 v39, 0
  v_and_b32 v2, 31, v1
  s_lshl_b32 s47, s3, 5
  v_add_u32 v2, s47, v2
  v_lshrrev_b32 v3, 1, v2
  v_and_b32 v3, 7, v3
  v_lshlrev_b32 v3, 4, v3
  v_lshl_add_u32 v2, v2, 7, v3
  v_lshrrev_b32 v3, 5, v1
  v_lshl_add_u32 v2, v3, 3, v2
  v_add_u32 v176, 102400, v2
  s_waitcnt lgkmcnt(0)
  s_mov_b32 s16, s6
  s_mov_b32 s17, s7
  s_mov_b32 s18, 0x3c00
  s_mov_b32 s19, 0x00020000
  s_add_u32 s72, s6, 0x1700000
  s_addc_u32 s73, s7, 0
  s_mov_b32 s74, 0x50000
  s_mov_b32 s75, 0x00020000
  s_mov_b32 s20, s24
  s_mov_b32 s21, s25
  s_mov_b32 s22, 0x280000
  s_mov_b32 s23, 0x00020000
  s_add_u32 s64, s6, 0x1100000
  s_addc_u32 s65, s7, 0
  s_mov_b32 s66, 0x280000
  s_mov_b32 s67, 0x00020000
  s_add_u32 s68, s6, 0x1400000
  s_addc_u32 s69, s7, 0
  s_mov_b32 s70, 0x280000
  s_mov_b32 s71, 0x00020000
  s_lshl_b32 s48, s3, 12
  s_add_u32 m0, s48, 102400
  s_mov_b32 s49, 0
  buffer_load_dwordx4 v179, s[20:23], s49 offen lds
  s_add_u32 m0, s48, 103424
  s_mov_b32 s49, 10240
  buffer_load_dwordx4 v180, s[20:23], s49 offen lds
  s_add_u32 m0, s48, 104448
  s_mov_b32 s49, 20480
  buffer_load_dwordx4 v179, s[20:23], s49 offen lds
  s_add_u32 m0, s48, 105472
  s_mov_b32 s49, 30720
  buffer_load_dwordx4 v180, s[20:23], s49 offen lds
  s_movk_i32 s38, 5120
  s_movk_i32 s39, 10240
  buffer_load_dwordx4 v[96:99], v177, s[16:19], s38 offen offset:0
  buffer_load_dwordx4 v[128:131], v177, s[16:19], s39 offen offset:0
  buffer_load_dwordx4 v[100:103], v177, s[16:19], s38 offen offset:32
  buffer_load_dwordx4 v[132:135], v177, s[16:19], s39 offen offset:32
  buffer_load_dwordx4 v[104:107], v177, s[16:19], s38 offen offset:64
  buffer_load_dwordx4 v[136:139], v177, s[16:19], s39 offen offset:64
  buffer_load_dwordx4 v[108:111], v177, s[16:19], s38 offen offset:96
  buffer_load_dwordx4 v[140:143], v177, s[16:19], s39 offen offset:96
  buffer_load_dwordx4 v[112:115], v177, s[16:19], s38 offen offset:128
  buffer_load_dwordx4 v[144:147], v177, s[16:19], s39 offen offset:128
  buffer_load_dwordx4 v[116:119], v177, s[16:19], s38 offen offset:160
  buffer_load_dwordx4 v[148:151], v177, s[16:19], s39 offen offset:160
  buffer_load_dwordx4 v[120:123], v177, s[16:19], s38 offen offset:192
  buffer_load_dwordx4 v[152:155], v177, s[16:19], s39 offen offset:192
  buffer_load_dwordx4 v[124:127], v177, s[16:19], s38 offen offset:224
  buffer_load_dwordx4 v[156:159], v177, s[16:19], s39 offen offset:224
  s_barrier
  ds_read_b128 v[40:43], v88
  ds_read_b64_tr_b16 v[56:57], v92 offset:0
  ds_read_b64_tr_b16 v[58:59], v92 offset:512
  ds_read_b64_tr_b16 v[60:61], v93 offset:0
  ds_read_b64_tr_b16 v[62:63], v93 offset:512
  ds_read_b128 v[44:47], v89
  ds_read_b64_tr_b16 v[64:65], v92 offset:2048
  ds_read_b64_tr_b16 v[66:67], v92 offset:2560
  ds_read_b64_tr_b16 v[68:69], v93 offset:2048
  ds_read_b64_tr_b16 v[70:71], v93 offset:2560
  ds_read_b128 v[48:51], v90
  ds_read_b64_tr_b16 v[72:73], v92 offset:4096
  ds_read_b64_tr_b16 v[74:75], v92 offset:4608
  ds_read_b64_tr_b16 v[76:77], v93 offset:4096
  ds_read_b64_tr_b16 v[78:79], v93 offset:4608
p3_loop_2:
  s_waitcnt lgkmcnt(10)
  v_mfma_f32_32x32x16_bf16 v[8:23], v[56:59], v[40:43], v[8:23]
  ds_read_b128 v[52:55], v91
  ds_read_b64_tr_b16 v[80:81], v92 offset:6144
  ds_read_b64_tr_b16 v[82:83], v92 offset:6656
  v_mfma_f32_32x32x16_bf16 v[24:39], v[60:63], v[40:43], v[24:39]
  ds_read_b64_tr_b16 v[84:85], v93 offset:6144
  ds_read_b64_tr_b16 v[86:87], v93 offset:6656
  s_waitcnt lgkmcnt(10)
  s_barrier
  s_add_u32 s46, s45, 20480
  s_cmp_eq_u32 s46, 102400
  s_cselect_b32 s46, 0, s46
  s_sub_u32 s47, s46, s45
  s_mov_b32 s45, s46
  v_mfma_f32_32x32x16_bf16 v[8:23], v[64:67], v[44:47], v[8:23]
  v_add_u32 v88, s47, v88
  v_add_u32 v89, s47, v89
  v_add_u32 v90, s47, v90
  v_add_u32 v91, s47, v91
  v_add_u32 v92, s47, v92
  v_add_u32 v93, s47, v93
  ds_read_b128 v[40:43], v88
  ds_read_b64_tr_b16 v[56:57], v92 offset:0
  ds_read_b64_tr_b16 v[58:59], v92 offset:512
  v_mfma_f32_32x32x16_bf16 v[24:39], v[68:71], v[44:47], v[24:39]
  ds_read_b64_tr_b16 v[60:61], v93 offset:0
  ds_read_b64_tr_b16 v[62:63], v93 offset:512
  s_waitcnt lgkmcnt(10)
  v_mfma_f32_32x32x16_bf16 v[8:23], v[72:75], v[48:51], v[8:23]
  ds_read_b128 v[44:47], v89
  ds_read_b64_tr_b16 v[64:65], v92 offset:2048
  ds_read_b64_tr_b16 v[66:67], v92 offset:2560
  v_mfma_f32_32x32x16_bf16 v[24:39], v[76:79], v[48:51], v[24:39]
  ds_read_b64_tr_b16 v[68:69], v93 offset:2048
  ds_read_b64_tr_b16 v[70:71], v93 offset:2560
  s_waitcnt lgkmcnt(10)
  v_mfma_f32_32x32x16_bf16 v[8:23], v[80:83], v[52:55], v[8:23]
  ds_read_b128 v[48:51], v90
  ds_read_b64_tr_b16 v[72:73], v92 offset:4096
  ds_read_b64_tr_b16 v[74:75], v92 offset:4608
  v_mfma_f32_32x32x16_bf16 v[24:39], v[84:87], v[52:55], v[24:39]
  ds_read_b64_tr_b16 v[76:77], v93 offset:4096
  ds_read_b64_tr_b16 v[78:79], v93 offset:4608
  s_add_u32 s44, s44, 1
  s_cmp_lt_u32 s44, 9
  s_cbranch_scc1 p3_loop_2
  s_waitcnt lgkmcnt(10)
  v_mfma_f32_32x32x16_bf16 v[8:23], v[56:59], v[40:43], v[8:23]
  ds_read_b128 v[52:55], v91
  ds_read_b64_tr_b16 v[80:81], v92 offset:6144
  ds_read_b64_tr_b16 v[82:83], v92 offset:6656
  v_mfma_f32_32x32x16_bf16 v[24:39], v[60:63], v[40:43], v[24:39]
  ds_read_b64_tr_b16 v[84:85], v93 offset:6144
  ds_read_b64_tr_b16 v[86:87], v93 offset:6656
  s_waitcnt lgkmcnt(10)
  v_mfma_f32_32x32x16_bf16 v[8:23], v[64:67], v[44:47], v[8:23]
  v_mfma_f32_32x32x16_bf16 v[24:39], v[68:71], v[44:47], v[24:39]
  s_waitcnt lgkmcnt(5)
  v_mfma_f32_32x32x16_bf16 v[8:23], v[72:75], v[48:51], v[8:23]
  v_mfma_f32_32x32x16_bf16 v[24:39], v[76:79], v[48:51], v[24:39]
  s_waitcnt lgkmcnt(0)
  v_mfma_f32_32x32x16_bf16 v[8:23], v[80:83], v[52:55], v[8:23]
  v_mfma_f32_32x32x16_bf16 v[24:39], v[84:87], v[52:55], v[24:39]
  s_nop 15
  s_waitcnt vmcnt(0)
  v_xor_b32 v181, 0, v176
  ds_read_b64 v[160:161], v181
  v_xor_b32 v182, 16, v176
  ds_read_b64 v[162:163], v182
  v_xor_b32 v183, 32, v176
  ds_read_b64 v[164:165], v183
  v_xor_b32 v184, 48, v176
  ds_read_b64 v[166:167], v184
  v_xor_b32 v185, 64, v176
  ds_read_b64 v[168:169], v185
  v_xor_b32 v186, 80, v176
  ds_read_b64 v[170:171], v186
  v_xor_b32 v187, 96, v176
  ds_read_b64 v[172:173], v187
  v_xor_b32 v188, 112, v176
  ds_read_b64 v[174:175], v188
  s_waitcnt lgkmcnt(7)
  v_lshlrev_b32 v2, 16, v160
  v_and_b32 v3, 0xffff0000, v160
  v_pk_fma_f32 v[8:9], v[8:9], v[96:97], v[2:3]
  v_lshlrev_b32 v4, 16, v161
  v_and_b32 v5, 0xffff0000, v161
  v_pk_fma_f32 v[10:11], v[10:11], v[98:99], v[4:5]
  v_cvt_pk_bf16_f32 v160, v8, v9
  v_cvt_pk_bf16_f32 v161, v10, v11
  s_waitcnt lgkmcnt(6)
  v_lshlrev_b32 v2, 16, v162
  v_and_b32 v3, 0xffff0000, v162
  v_pk_fma_f32 v[12:13], v[12:13], v[100:101], v[2:3]
  v_lshlrev_b32 v4, 16, v163
  v_and_b32 v5, 0xffff0000, v163
  v_pk_fma_f32 v[14:15], v[14:15], v[102:103], v[4:5]
  v_cvt_pk_bf16_f32 v162, v12, v13
  v_cvt_pk_bf16_f32 v163, v14, v15
  s_waitcnt lgkmcnt(5)
  v_lshlrev_b32 v2, 16, v164
  v_and_b32 v3, 0xffff0000, v164
  v_pk_fma_f32 v[16:17], v[16:17], v[104:105], v[2:3]
  v_lshlrev_b32 v4, 16, v165
  v_and_b32 v5, 0xffff0000, v165
  v_pk_fma_f32 v[18:19], v[18:19], v[106:107], v[4:5]
  v_cvt_pk_bf16_f32 v164, v16, v17
  v_cvt_pk_bf16_f32 v165, v18, v19
  s_waitcnt lgkmcnt(4)
  v_lshlrev_b32 v2, 16, v166
  v_and_b32 v3, 0xffff0000, v166
  v_pk_fma_f32 v[20:21], v[20:21], v[108:109], v[2:3]
  v_lshlrev_b32 v4, 16, v167
  v_and_b32 v5, 0xffff0000, v167
  v_pk_fma_f32 v[22:23], v[22:23], v[110:111], v[4:5]
  v_cvt_pk_bf16_f32 v166, v20, v21
  v_cvt_pk_bf16_f32 v167, v22, v23
  s_waitcnt lgkmcnt(3)
  v_lshlrev_b32 v2, 16, v168
  v_and_b32 v3, 0xffff0000, v168
  v_pk_fma_f32 v[24:25], v[24:25], v[112:113], v[2:3]
  v_lshlrev_b32 v4, 16, v169
  v_and_b32 v5, 0xffff0000, v169
  v_pk_fma_f32 v[26:27], v[26:27], v[114:115], v[4:5]
  v_cvt_pk_bf16_f32 v168, v24, v25
  v_cvt_pk_bf16_f32 v169, v26, v27
  s_waitcnt lgkmcnt(2)
  v_lshlrev_b32 v2, 16, v170
  v_and_b32 v3, 0xffff0000, v170
  v_pk_fma_f32 v[28:29], v[28:29], v[116:117], v[2:3]
  v_lshlrev_b32 v4, 16, v171
  v_and_b32 v5, 0xffff0000, v171
  v_pk_fma_f32 v[30:31], v[30:31], v[118:119], v[4:5]
  v_cvt_pk_bf16_f32 v170, v28, v29
  v_cvt_pk_bf16_f32 v171, v30, v31
  s_waitcnt lgkmcnt(1)
  v_lshlrev_b32 v2, 16, v172
  v_and_b32 v3, 0xffff0000, v172
  v_pk_fma_f32 v[32:33], v[32:33], v[120:121], v[2:3]
  v_lshlrev_b32 v4, 16, v173
  v_and_b32 v5, 0xffff0000, v173
  v_pk_fma_f32 v[34:35], v[34:35], v[122:123], v[4:5]
  v_cvt_pk_bf16_f32 v172, v32, v33
  v_cvt_pk_bf16_f32 v173, v34, v35
  s_waitcnt lgkmcnt(0)
  v_lshlrev_b32 v2, 16, v174
  v_and_b32 v3, 0xffff0000, v174
  v_pk_fma_f32 v[36:37], v[36:37], v[124:125], v[2:3]
  v_lshlrev_b32 v4, 16, v175
  v_and_b32 v5, 0xffff0000, v175
  v_pk_fma_f32 v[38:39], v[38:39], v[126:127], v[4:5]
  v_cvt_pk_bf16_f32 v174, v36, v37
  v_cvt_pk_bf16_f32 v175, v38, v39
  ds_write_b64 v181, v[160:161]
  ds_write_b64 v182, v[162:163]
  ds_write_b64 v183, v[164:165]
  ds_write_b64 v184, v[166:167]
  ds_write_b64 v185, v[168:169]
  ds_write_b64 v186, v[170:171]
  ds_write_b64 v187, v[172:173]
  ds_write_b64 v188, v[174:175]
  s_lshl_b32 s48, s3, 12
  s_add_u32 s48, s48, 102400
  v_lshlrev_b32 v2, 4, v1
  v_add_u32 v2, s48, v2
  s_waitcnt lgkmcnt(0)
  ds_read_b128 v[40:43], v2 offset:0
  ds_read_b128 v[44:47], v2 offset:1024
  ds_read_b128 v[48:51], v2 offset:2048
  ds_read_b128 v[52:55], v2 offset:3072
  s_mov_b32 s49, 0
  s_waitcnt lgkmcnt(3)
  buffer_store_dwordx4 v[40:43], v179, s[64:67], s49 offen
  s_mov_b32 s49, 10240
  s_waitcnt lgkmcnt(2)
  buffer_store_dwordx4 v[44:47], v180, s[64:67], s49 offen
  s_mov_b32 s49, 20480
  s_waitcnt lgkmcnt(1)
  buffer_store_dwordx4 v[48:51], v179, s[64:67], s49 offen
  s_mov_b32 s49, 30720
  s_waitcnt lgkmcnt(0)
  buffer_store_dwordx4 v[52:55], v180, s[64:67], s49 offen
  v_pk_mul_f32 v[128:129], v[128:129], v[8:9]
  v_pk_mul_f32 v[130:131], v[130:131], v[10:11]
  v_pk_mul_f32 v[132:133], v[132:133], v[12:13]
  v_pk_mul_f32 v[134:135], v[134:135], v[14:15]
  v_pk_mul_f32 v[136:137], v[136:137], v[16:17]
  v_pk_mul_f32 v[138:139], v[138:139], v[18:19]
  v_pk_mul_f32 v[140:141], v[140:141], v[20:21]
  v_pk_mul_f32 v[142:143], v[142:143], v[22:23]
  v_pk_mul_f32 v[144:145], v[144:145], v[24:25]
  v_pk_mul_f32 v[146:147], v[146:147], v[26:27]
  v_pk_mul_f32 v[148:149], v[148:149], v[28:29]
  v_pk_mul_f32 v[150:151], v[150:151], v[30:31]
  v_pk_mul_f32 v[152:153], v[152:153], v[32:33]
  v_pk_mul_f32 v[154:155], v[154:155], v[34:35]
  v_pk_mul_f32 v[156:157], v[156:157], v[36:37]
  v_pk_mul_f32 v[158:159], v[158:159], v[38:39]
  v_cvt_pk_bf16_f32 v96, v128, v129
  v_cvt_pk_bf16_f32 v97, v130, v131
  ds_write_b64 v181, v[96:97]
  v_cvt_pk_bf16_f32 v98, v132, v133
  v_cvt_pk_bf16_f32 v99, v134, v135
  ds_write_b64 v182, v[98:99]
  v_cvt_pk_bf16_f32 v100, v136, v137
  v_cvt_pk_bf16_f32 v101, v138, v139
  ds_write_b64 v183, v[100:101]
  v_cvt_pk_bf16_f32 v102, v140, v141
  v_cvt_pk_bf16_f32 v103, v142, v143
  ds_write_b64 v184, v[102:103]
  v_cvt_pk_bf16_f32 v104, v144, v145
  v_cvt_pk_bf16_f32 v105, v146, v147
  ds_write_b64 v185, v[104:105]
  v_cvt_pk_bf16_f32 v106, v148, v149
  v_cvt_pk_bf16_f32 v107, v150, v151
  ds_write_b64 v186, v[106:107]
  v_cvt_pk_bf16_f32 v108, v152, v153
  v_cvt_pk_bf16_f32 v109, v154, v155
  ds_write_b64 v187, v[108:109]
  v_cvt_pk_bf16_f32 v110, v156, v157
  v_cvt_pk_bf16_f32 v111, v158, v159
  ds_write_b64 v188, v[110:111]
  s_lshl_b32 s48, s3, 12
  s_add_u32 s48, s48, 102400
  v_lshlrev_b32 v2, 4, v1
  v_add_u32 v2, s48, v2
  s_waitcnt lgkmcnt(0)
  ds_read_b128 v[56:59], v2 offset:0
  ds_read_b128 v[60:63], v2 offset:1024
  ds_read_b128 v[64:67], v2 offset:2048
  ds_read_b128 v[68:71], v2 offset:3072
  s_mov_b32 s49, 0
  s_waitcnt lgkmcnt(3)
  buffer_store_dwordx4 v[56:59], v179, s[68:71], s49 offen
  s_mov_b32 s49, 10240
  s_waitcnt lgkmcnt(2)
  buffer_store_dwordx4 v[60:63], v180, s[68:71], s49 offen
  s_mov_b32 s49, 20480
  s_waitcnt lgkmcnt(1)
  buffer_store_dwordx4 v[64:67], v179, s[68:71], s49 offen
  s_mov_b32 s49, 30720
  s_waitcnt lgkmcnt(0)
  buffer_store_dwordx4 v[68:71], v180, s[68:71], s49 offen
  v_pk_add_f32 v[4:5], v[8:9], v[12:13]
  v_pk_add_f32 v[6:7], v[10:11], v[14:15]
  v_pk_add_f32 v[4:5], v[4:5], v[16:17]
  v_pk_add_f32 v[6:7], v[6:7], v[18:19]
  v_pk_add_f32 v[4:5], v[4:5], v[20:21]
  v_pk_add_f32 v[6:7], v[6:7], v[22:23]
  v_pk_add_f32 v[4:5], v[4:5], v[24:25]
  v_pk_add_f32 v[6:7], v[6:7], v[26:27]
  v_pk_add_f32 v[4:5], v[4:5], v[28:29]
  v_pk_add_f32 v[6:7], v[6:7], v[30:31]
  v_pk_add_f32 v[4:5], v[4:5], v[32:33]
  v_pk_add_f32 v[6:7], v[6:7], v[34:35]
  v_pk_add_f32 v[4:5], v[4:5], v[36:37]
  v_pk_add_f32 v[6:7], v[6:7], v[38:39]
  v_pk_add_f32 v[4:5], v[4:5], v[6:7]
  v_add_f32 v160, v4, v5
  v_mul_f32 v2, 0xbd000000, v160
  v_mov_b32 v3, v2
  v_pk_add_f32 v[8:9], v[8:9], v[2:3]
  v_pk_add_f32 v[10:11], v[10:11], v[2:3]
  v_pk_add_f32 v[12:13], v[12:13], v[2:3]
  v_pk_add_f32 v[14:15], v[14:15], v[2:3]
  v_pk_add_f32 v[16:17], v[16:17], v[2:3]
  v_pk_add_f32 v[18:19], v[18:19], v[2:3]
  v_pk_add_f32 v[20:21], v[20:21], v[2:3]
  v_pk_add_f32 v[22:23], v[22:23], v[2:3]
  v_pk_add_f32 v[24:25], v[24:25], v[2:3]
  v_pk_add_f32 v[26:27], v[26:27], v[2:3]
  v_pk_add_f32 v[28:29], v[28:29], v[2:3]
  v_pk_add_f32 v[30:31], v[30:31], v[2:3]
  v_pk_add_f32 v[32:33], v[32:33], v[2:3]
  v_pk_add_f32 v[34:35], v[34:35], v[2:3]
  v_pk_add_f32 v[36:37], v[36:37], v[2:3]
  v_pk_add_f32 v[38:39], v[38:39], v[2:3]
  v_pk_mul_f32 v[4:5], v[8:9], v[8:9]
  v_pk_mul_f32 v[6:7], v[10:11], v[10:11]
  v_pk_fma_f32 v[4:5], v[12:13], v[12:13], v[4:5]
  v_pk_fma_f32 v[6:7], v[14:15], v[14:15], v[6:7]
  v_pk_fma_f32 v[4:5], v[16:17], v[16:17], v[4:5]
  v_pk_fma_f32 v[6:7], v[18:19], v[18:19], v[6:7]
  v_pk_fma_f32 v[4:5], v[20:21], v[20:21], v[4:5]
  v_pk_fma_f32 v[6:7], v[22:23], v[22:23], v[6:7]
  v_pk_fma_f32 v[4:5], v[24:25], v[24:25], v[4:5]
  v_pk_fma_f32 v[6:7], v[26:27], v[26:27], v[6:7]
  v_pk_fma_f32 v[4:5], v[28:29], v[28:29], v[4:5]
  v_pk_fma_f32 v[6:7], v[30:31], v[30:31], v[6:7]
  v_pk_fma_f32 v[4:5], v[32:33], v[32:33], v[4:5]
  v_pk_fma_f32 v[6:7], v[34:35], v[34:35], v[6:7]
  v_pk_fma_f32 v[4:5], v[36:37], v[36:37], v[4:5]
  v_pk_fma_f32 v[6:7], v[38:39], v[38:39], v[6:7]
  v_pk_add_f32 v[4:5], v[4:5], v[6:7]
  v_add_f32 v161, v4, v5
  buffer_store_dwordx2 v[160:161], v178, s[72:75], 0 offen
  s_endpgm
p3_special:
  s_cmp_ge_u32 s3, 6
  s_cbranch_scc1 p3_END
  s_sub_u32 s61, s2, 224
  s_lshl_b32 s37, s61, 7
  s_cmp_lt_u32 s3, 4
  s_cbranch_scc1 p3_scomp
  s_mov_b32 s36, 0
  s_sub_u32 s43, s3, 4
  v_lshrrev_b32 v2, 3, v1
  s_lshl_b32 s47, s43, 3
  v_add_u32 v2, s47, v2
  v_lshrrev_b32 v3, 1, v2
  v_and_b32 v3, 7, v3
  v_and_b32 v4, 7, v1
  v_xor_b32 v3, v3, v4
  v_lshlrev_b32 v3, 4, v3
  s_mov_b32 s47, 1280
  v_mad_u32_u24 v2, v2, s47, v3
  v_add_u32 v8, s36, v2
  v_add_u32 v9, 20480, v8
  v_lshrrev_b32 v2, 3, v1
  s_lshl_b32 s47, s43, 3
  v_add_u32 v2, s47, v2
  v_lshrrev_b32 v3, 4, v1
  v_and_b32 v3, 1, v3
  v_lshlrev_b32 v3, 2, v3
  v_and_b32 v4, 7, v1
  v_xor_b32 v3, v3, v4
  v_lshlrev_b32 v3, 4, v3
  s_mov_b32 s47, 3456
  v_mad_u32_u24 v2, v2, s47, v3
  v_add_u32 v10, s37, v2
  v_add_u32 v11, 55296, v10
  v_add_u32 v12, 110592, v10
  v_add_u32 v13, 165888, v10
  v_mov_b32 v14, v10
  v_mov_b32 v15, v11
  v_mov_b32 v16, v12
  v_mov_b32 v17, v13
  s_lshl_b32 s40, s43, 10
  s_mov_b32 s41, 0
  s_mov_b32 s42, 0
  s_mov_b32 s45, 0
  s_mov_b32 s44, 0
  s_waitcnt lgkmcnt(0)
  s_add_u32 s8, s6, 0x4000
  s_addc_u32 s9, s7, 0
  s_mov_b32 s10, 0xa00
  s_mov_b32 s11, 0x00020000
  s_mov_b32 s12, s26
  s_mov_b32 s13, s27
  s_mov_b32 s14, 0x21c000
  s_mov_b32 s15, 0x00020000
  s_mov_b32 s16, s28
  s_mov_b32 s17, s29
  s_mov_b32 s18, 0x21c000
  s_mov_b32 s19, 0x00020000
  s_add_u32 s47, s40, 0
  s_add_u32 m0, s47, 0
  s_nop 0
  buffer_load_dwordx4 v8, s[8:11], s41 offen lds
  s_add_u32 m0, s47, 2048
  s_nop 0
  buffer_load_dwordx4 v9, s[8:11], s41 offen lds
  s_add_u32 m0, s47, 4096
  s_nop 0
  buffer_load_dwordx4 v10, s[12:15], s42 offen lds
  s_add_u32 m0, s47, 6144
  s_nop 0
  buffer_load_dwordx4 v11, s[12:15], s42 offen lds
  s_add_u32 m0, s47, 8192
  s_nop 0
  buffer_load_dwordx4 v12, s[12:15], s42 offen lds
  s_add_u32 m0, s47, 10240
  s_nop 0
  buffer_load_dwordx4 v13, s[12:15], s42 offen lds
  s_add_u32 m0, s47, 12288
  s_nop 0
  buffer_load_dwordx4 v14, s[16:19], s42 offen lds
  s_add_u32 m0, s47, 14336
  s_nop 0
  buffer_load_dwordx4 v15, s[16:19], s42 offen lds
  s_add_u32 m0, s47, 16384
  s_nop 0
  buffer_load_dwordx4 v16, s[16:19], s42 offen lds
  s_add_u32 m0, s47, 18432
  s_nop 0
  buffer_load_dwordx4 v17, s[16:19], s42 offen lds
  s_add_u32 s41, s41, 128
  s_add_u32 s42, s42, 221184
  s_add_u32 s47, s40, 20480
  s_add_u32 m0, s47, 0
  s_nop 0
  buffer_load_dwordx4 v8, s[8:11], s41 offen lds
  s_add_u32 m0, s47, 2048
  s_nop 0
  buffer_load_dwordx4 v9, s[8:11], s41 offen lds
  s_add_u32 m0, s47, 4096
  s_nop 0
  buffer_load_dwordx4 v10, s[12:15], s42 offen lds
  s_add_u32 m0, s47, 6144
  s_nop 0
  buffer_load_dwordx4 v11, s[12:15], s42 offen lds
  s_add_u32 m0, s47, 8192
  s_nop 0
  buffer_load_dwordx4 v12, s[12:15], s42 offen lds
  s_add_u32 m0, s47, 10240
  s_nop 0
  buffer_load_dwordx4 v13, s[12:15], s42 offen lds
  s_add_u32 m0, s47, 12288
  s_nop 0
  buffer_load_dwordx4 v14, s[16:19], s42 offen lds
  s_add_u32 m0, s47, 14336
  s_nop 0
  buffer_load_dwordx4 v15, s[16:19], s42 offen lds
  s_add_u32 m0, s47, 16384
  s_nop 0
  buffer_load_dwordx4 v16, s[16:19], s42 offen lds
  s_add_u32 m0, s47, 18432
  s_nop 0
  buffer_load_dwordx4 v17, s[16:19], s42 offen lds
  s_add_u32 s41, s41, 128
  s_add_u32 s42, s42, 221184
  s_add_u32 s47, s40, 40960
  s_add_u32 m0, s47, 0
  s_nop 0
  buffer_load_dwordx4 v8, s[8:11], s41 offen lds
  s_add_u32 m0, s47, 2048
  s_nop 0
  buffer_load_dwordx4 v9, s[8:11], s41 offen lds
  s_add_u32 m0, s47, 4096
  s_nop 0
  buffer_load_dwordx4 v10, s[12:15], s42 offen lds
  s_add_u32 m0, s47, 6144
  s_nop 0
  buffer_load_dwordx4 v11, s[12:15], s42 offen lds
  s_add_u32 m0, s47, 8192
  s_nop 0
  buffer_load_dwordx4 v12, s[12:15], s42 offen lds
  s_add_u32 m0, s47, 10240
  s_nop 0
  buffer_load_dwordx4 v13, s[12:15], s42 offen lds
  s_add_u32 m0, s47, 12288
  s_nop 0
  buffer_load_dwordx4 v14, s[16:19], s42 offen lds
  s_add_u32 m0, s47, 14336
  s_nop 0
  buffer_load_dwordx4 v15, s[16:19], s42 offen lds
  s_add_u32 m0, s47, 16384
  s_nop 0
  buffer_load_dwordx4 v16, s[16:19], s42 offen lds
  s_add_u32 m0, s47, 18432
  s_nop 0
  buffer_load_dwordx4 v17, s[16:19], s42 offen lds
  s_add_u32 s41, s41, 128
  s_add_u32 s42, s42, 221184
  s_waitcnt vmcnt(20)
  s_barrier
  s_add_u32 s47, s40, 61440
  s_add_u32 m0, s47, 0
  s_nop 0
  buffer_load_dwordx4 v8, s[8:11], s41 offen lds
  s_add_u32 m0, s47, 2048
  s_nop 0
  buffer_load_dwordx4 v9, s[8:11], s41 offen lds
  s_add_u32 m0, s47, 4096
  s_nop 0
  buffer_load_dwordx4 v10, s[12:15], s42 offen lds
  s_add_u32 m0, s47, 6144
  s_nop 0
  buffer_load_dwordx4 v11, s[12:15], s42 offen lds
  s_add_u32 m0, s47, 8192
  s_nop 0
  buffer_load_dwordx4 v12, s[12:15], s42 offen lds
  s_add_u32 m0, s47, 10240
  s_nop 0
  buffer_load_dwordx4 v13, s[12:15], s42 offen lds
  s_add_u32 m0, s47, 12288
  s_nop 0
  buffer_load_dwordx4 v14, s[16:19], s42 offen lds
  s_add_u32 m0, s47, 14336
  s_nop 0
  buffer_load_dwordx4 v15, s[16:19], s42 offen lds
  s_add_u32 m0, s47, 16384
  s_nop 0
  buffer_load_dwordx4 v16, s[16:19], s42 offen lds
  s_add_u32 m0, s47, 18432
  s_nop 0
  buffer_load_dwordx4 v17, s[16:19], s42 offen lds
  s_add_u32 s41, s41, 128
  s_add_u32 s42, s42, 221184
  s_mov_b32 s45, 81920
p3_ll_3:
  s_waitcnt vmcnt(20)
  s_barrier
  s_add_u32 s47, s40, s45
  s_add_u32 m0, s47, 0
  s_nop 0
  buffer_load_dwordx4 v8, s[8:11], s41 offen lds
  s_add_u32 m0, s47, 2048
  s_nop 0
  buffer_load_dwordx4 v9, s[8:11], s41 offen lds
  s_add_u32 m0, s47, 4096
  s_nop 0
  buffer_load_dwordx4 v10, s[12:15], s42 offen lds
  s_add_u32 m0, s47, 6144
  s_nop 0
  buffer_load_dwordx4 v11, s[12:15], s42 offen lds
  s_add_u32 m0, s47, 8192
  s_nop 0
  buffer_load_dwordx4 v12, s[12:15], s42 offen lds
  s_add_u32 m0, s47, 10240
  s_nop 0
  buffer_load_dwordx4 v13, s[12:15], s42 offen lds
  s_add_u32 m0, s47, 12288
  s_nop 0
  buffer_load_dwordx4 v14, s[16:19], s42 offen lds
  s_add_u32 m0, s47, 14336
  s_nop 0
  buffer_load_dwordx4 v15, s[16:19], s42 offen lds
  s_add_u32 m0, s47, 16384
  s_nop 0
  buffer_load_dwordx4 v16, s[16:19], s42 offen lds
  s_add_u32 m0, s47, 18432
  s_nop 0
  buffer_load_dwordx4 v17, s[16:19], s42 offen lds
  s_add_u32 s41, s41, 128
  s_add_u32 s42, s42, 221184
  s_add_u32 s45, s45, 20480
  s_cmp_eq_u32 s45, 102400
  s_cselect_b32 s45, 0, s45
  s_add_u32 s44, s44, 1
  s_cmp_lt_u32 s44, 6
  s_cbranch_scc1 p3_ll_3
  s_waitcnt vmcnt(20)
  s_barrier
  s_waitcnt vmcnt(10)
  s_barrier
  s_waitcnt vmcnt(0)
  s_barrier
  s_endpgm
p3_scomp:
  v_and_b32 v2, 31, v1
  v_lshrrev_b32 v3, 1, v2
  v_and_b32 v3, 7, v3
  v_lshrrev_b32 v4, 5, v1
  v_xor_b32 v3, v3, v4
  v_lshlrev_b32 v3, 4, v3
  v_lshl_add_u32 v56, v2, 7, v3
  v_xor_b32 v57, 32, v56
  v_xor_b32 v58, 64, v56
  v_xor_b32 v59, 96, v56
  v_lshlrev_b32 v2, 3, v4
  v_and_b32 v3, 15, v1
  v_lshrrev_b32 v3, 2, v3
  v_add_u32 v2, v2, v3
  v_mul_u32_u24 v2, 128, v2
  v_lshrrev_b32 v3, 4, v1
  v_and_b32 v3, 1, v3
  v_lshl_add_u32 v2, v3, 5, v2
  v_and_b32 v3, 3, v1
  v_lshl_add_u32 v2, v3, 3, v2
  v_lshrrev_b32 v3, 3, v1
  v_and_b32 v3, 1, v3
  v_lshl_add_u32 v2, v3, 6, v2
  v_add_u32 v60, 4096, v2
  s_and_b32 s47, s3, 1
  s_lshl_b32 s47, s47, 6
  v_xor_b32 v60, s47, v60
  s_lshr_b32 s47, s3, 1
  s_lshl_b32 s47, s47, 13
  v_add_u32 v60, s47, v60
  v_xor_b32 v61, 64, v60
  s_mov_b32 s45, 0
  s_mov_b32 s44, 0
  v_mov_b32 v8, 0
  v_mov_b32 v9, 0
  v_mov_b32 v10, 0
  v_mov_b32 v11, 0
  v_mov_b32 v12, 0
  v_mov_b32 v13, 0
  v_mov_b32 v14, 0
  v_mov_b32 v15, 0
  v_mov_b32 v16, 0
  v_mov_b32 v17, 0
  v_mov_b32 v18, 0
  v_mov_b32 v19, 0
  v_mov_b32 v20, 0
  v_mov_b32 v21, 0
  v_mov_b32 v22, 0
  v_mov_b32 v23, 0
  s_waitcnt lgkmcnt(0)
  s_add_u32 s20, s6, 0x8000
  s_addc_u32 s21, s7, 0
  s_mov_b32 s22, 0xd800
  s_mov_b32 s23, 0x00020000
  s_barrier
  ds_read_b128 v[24:27], v56
  ds_read_b64_tr_b16 v[40:41], v60 offset:0
  ds_read_b64_tr_b16 v[42:43], v60 offset:512
  ds_read_b128 v[28:31], v57
  ds_read_b64_tr_b16 v[44:45], v60 offset:2048
  ds_read_b64_tr_b16 v[46:47], v60 offset:2560
  ds_read_b128 v[32:35], v58
  ds_read_b64_tr_b16 v[48:49], v60 offset:4096
  ds_read_b64_tr_b16 v[50:51], v60 offset:4608
p3_loop_4:
  s_waitcnt lgkmcnt(6)
  v_mfma_f32_32x32x16_bf16 v[8:23], v[40:43], v[24:27], v[8:23]
  ds_read_b128 v[36:39], v59
  ds_read_b64_tr_b16 v[52:53], v60 offset:6144
  ds_read_b64_tr_b16 v[54:55], v60 offset:6656
  s_waitcnt lgkmcnt(6)
  s_barrier
  s_add_u32 s46, s45, 20480
  s_cmp_eq_u32 s46, 102400
  s_cselect_b32 s46, 0, s46
  s_sub_u32 s47, s46, s45
  s_mov_b32 s45, s46
  v_mfma_f32_32x32x16_bf16 v[8:23], v[44:47], v[28:31], v[8:23]
  v_add_u32 v56, s47, v56
  v_add_u32 v57, s47, v57
  v_add_u32 v58, s47, v58
  v_add_u32 v59, s47, v59
  v_add_u32 v60, s47, v60
  v_add_u32 v61, s47, v61
  ds_read_b128 v[24:27], v56
  ds_read_b64_tr_b16 v[40:41], v60 offset:0
  ds_read_b64_tr_b16 v[42:43], v60 offset:512
  s_waitcnt lgkmcnt(6)
  v_mfma_f32_32x32x16_bf16 v[8:23], v[48:51], v[32:35], v[8:23]
  ds_read_b128 v[28:31], v57
  ds_read_b64_tr_b16 v[44:45], v60 offset:2048
  ds_read_b64_tr_b16 v[46:47], v60 offset:2560
  s_waitcnt lgkmcnt(6)
  v_mfma_f32_32x32x16_bf16 v[8:23], v[52:55], v[36:39], v[8:23]
  ds_read_b128 v[32:35], v58
  ds_read_b64_tr_b16 v[48:49], v60 offset:4096
  ds_read_b64_tr_b16 v[50:51], v60 offset:4608
  s_add_u32 s44, s44, 1
  s_cmp_lt_u32 s44, 9
  s_cbranch_scc1 p3_loop_4
  s_waitcnt lgkmcnt(6)
  v_mfma_f32_32x32x16_bf16 v[8:23], v[40:43], v[24:27], v[8:23]
  ds_read_b128 v[36:39], v59
  ds_read_b64_tr_b16 v[52:53], v60 offset:6144
  ds_read_b64_tr_b16 v[54:55], v60 offset:6656
  s_waitcnt lgkmcnt(6)
  v_mfma_f32_32x32x16_bf16 v[8:23], v[44:47], v[28:31], v[8:23]
  s_waitcnt lgkmcnt(3)
  v_mfma_f32_32x32x16_bf16 v[8:23], v[48:51], v[32:35], v[8:23]
  s_waitcnt lgkmcnt(0)
  v_mfma_f32_32x32x16_bf16 v[8:23], v[52:55], v[36:39], v[8:23]
  s_nop 15
  s_lshr_b32 s38, s3, 1
  s_mul_i32 s38, s38, 1728
  s_lshl_b32 s39, s61, 6
  s_add_u32 s38, s38, s39
  s_and_b32 s39, s3, 1
  s_lshl_b32 s39, s39, 5
  s_add_u32 s38, s38, s39
  v_lshrrev_b32 v3, 5, v1
  v_lshlrev_b32 v3, 2, v3
  v_add_u32 v3, s38, v3
  v_lshlrev_b32 v3, 4, v3
  v_and_b32 v2, 31, v1
  v_lshl_add_u32 v3, v2, 3, v3
  v_cmp_gt_u32 vcc, 2, v2
  s_and_saveexec_b64 s[40:41], vcc
  v_and_b32 v4, 0xffff0000, v8
  v_sub_f32 v5, v8, v4
  v_cvt_pk_bf16_f32 v32, v4, v5
  v_mov_b32 v33, v32
  buffer_store_dwordx2 v[32:33], v3, s[20:23], 0 offen offset:0
  s_nop 1
  v_and_b32 v4, 0xffff0000, v9
  v_sub_f32 v5, v9, v4
  v_cvt_pk_bf16_f32 v34, v4, v5
  v_mov_b32 v35, v34
  buffer_store_dwordx2 v[34:35], v3, s[20:23], 0 offen offset:16
  s_nop 1
  v_and_b32 v4, 0xffff0000, v10
  v_sub_f32 v5, v10, v4
  v_cvt_pk_bf16_f32 v36, v4, v5
  v_mov_b32 v37, v36
  buffer_store_dwordx2 v[36:37], v3, s[20:23], 0 offen offset:32
  s_nop 1
  v_and_b32 v4, 0xffff0000, v11
  v_sub_f32 v5, v11, v4
  v_cvt_pk_bf16_f32 v38, v4, v5
  v_mov_b32 v39, v38
  buffer_store_dwordx2 v[38:39], v3, s[20:23], 0 offen offset:48
  s_nop 1
  v_and_b32 v4, 0xffff0000, v12
  v_sub_f32 v5, v12, v4
  v_cvt_pk_bf16_f32 v32, v4, v5
  v_mov_b32 v33, v32
  buffer_store_dwordx2 v[32:33], v3, s[20:23], 0 offen offset:128
  s_nop 1
  v_and_b32 v4, 0xffff0000, v13
  v_sub_f32 v5, v13, v4
  v_cvt_pk_bf16_f32 v34, v4, v5
  v_mov_b32 v35, v34
  buffer_store_dwordx2 v[34:35], v3, s[20:23], 0 offen offset:144
  s_nop 1
  v_and_b32 v4, 0xffff0000, v14
  v_sub_f32 v5, v14, v4
  v_cvt_pk_bf16_f32 v36, v4, v5
  v_mov_b32 v37, v36
  buffer_store_dwordx2 v[36:37], v3, s[20:23], 0 offen offset:160
  s_nop 1
  v_and_b32 v4, 0xffff0000, v15
  v_sub_f32 v5, v15, v4
  v_cvt_pk_bf16_f32 v38, v4, v5
  v_mov_b32 v39, v38
  buffer_store_dwordx2 v[38:39], v3, s[20:23], 0 offen offset:176
  s_nop 1
  v_and_b32 v4, 0xffff0000, v16
  v_sub_f32 v5, v16, v4
  v_cvt_pk_bf16_f32 v32, v4, v5
  v_mov_b32 v33, v32
  buffer_store_dwordx2 v[32:33], v3, s[20:23], 0 offen offset:256
  s_nop 1
  v_and_b32 v4, 0xffff0000, v17
  v_sub_f32 v5, v17, v4
  v_cvt_pk_bf16_f32 v34, v4, v5
  v_mov_b32 v35, v34
  buffer_store_dwordx2 v[34:35], v3, s[20:23], 0 offen offset:272
  s_nop 1
  v_and_b32 v4, 0xffff0000, v18
  v_sub_f32 v5, v18, v4
  v_cvt_pk_bf16_f32 v36, v4, v5
  v_mov_b32 v37, v36
  buffer_store_dwordx2 v[36:37], v3, s[20:23], 0 offen offset:288
  s_nop 1
  v_and_b32 v4, 0xffff0000, v19
  v_sub_f32 v5, v19, v4
  v_cvt_pk_bf16_f32 v38, v4, v5
  v_mov_b32 v39, v38
  buffer_store_dwordx2 v[38:39], v3, s[20:23], 0 offen offset:304
  s_nop 1
  v_and_b32 v4, 0xffff0000, v20
  v_sub_f32 v5, v20, v4
  v_cvt_pk_bf16_f32 v32, v4, v5
  v_mov_b32 v33, v32
  buffer_store_dwordx2 v[32:33], v3, s[20:23], 0 offen offset:384
  s_nop 1
  v_and_b32 v4, 0xffff0000, v21
  v_sub_f32 v5, v21, v4
  v_cvt_pk_bf16_f32 v34, v4, v5
  v_mov_b32 v35, v34
  buffer_store_dwordx2 v[34:35], v3, s[20:23], 0 offen offset:400
  s_nop 1
  v_and_b32 v4, 0xffff0000, v22
  v_sub_f32 v5, v22, v4
  v_cvt_pk_bf16_f32 v36, v4, v5
  v_mov_b32 v37, v36
  buffer_store_dwordx2 v[36:37], v3, s[20:23], 0 offen offset:416
  s_nop 1
  v_and_b32 v4, 0xffff0000, v23
  v_sub_f32 v5, v23, v4
  v_cvt_pk_bf16_f32 v38, v4, v5
  v_mov_b32 v39, v38
  buffer_store_dwordx2 v[38:39], v3, s[20:23], 0 offen offset:432
  s_nop 1
p3_END:
  s_endpgm
.section .rodata,"a"
.p2align 6
.amdhsa_kernel p3_kernel
  .amdhsa_next_free_vgpr 192
  .amdhsa_next_free_sgpr 102
  .amdhsa_accum_offset 192
  .amdhsa_group_segment_fixed_size 0
  .amdhsa_kernarg_size 96
  .amdhsa_user_sgpr_count 2
  .amdhsa_user_sgpr_kernarg_segment_ptr 1
  .amdhsa_system_sgpr_workgroup_id_x 1
.end_amdhsa_kernel
.text
.globl p4_kernel
.p2align 8
.type p4_kernel,@function
p4_kernel:
  s_cmp_ge_u32 s2, 224
  s_cbranch_scc1 p4_END
  s_load_dwordx2 s[4:5], s[0:1], 32
  s_load_dwordx2 s[24:25], s[0:1], 40
  s_load_dwordx2 s[6:7], s[0:1], 88
  s_load_dwordx2 s[26:27], s[0:1], 48
  v_lshrrev_b32 v1, 6, v0
  s_nop 0
  v_readfirstlane_b32 s3, v1
  v_and_b32 v1, 63, v0
  s_nop 3
  s_and_b32 s33, s2, 7
  s_lshr_b32 s34, s2, 3
  s_and_b32 s35, s33, 1
  s_lshl_b32 s35, s35, 2
  s_and_b32 s60, s34, 3
  s_add_u32 s60, s60, s35
  s_lshl_b32 s60, s60, 8
  s_lshr_b32 s33, s33, 1
  s_mul_i32 s33, s33, 7
  s_lshr_b32 s34, s34, 2
  s_add_u32 s61, s33, s34
  s_cmp_ge_u32 s61, 27
  s_cbranch_scc1 p4_END
  s_lshl_b32 s37, s61, 7
  s_cmp_lt_u32 s3, 8
  s_cbranch_scc1 p4_comp
  s_mul_i32 s36, s60, 1280
  s_sub_u32 s43, s3, 8
  v_lshrrev_b32 v2, 3, v1
  s_lshl_b32 s47, s43, 3
  v_add_u32 v2, s47, v2
  v_lshrrev_b32 v3, 1, v2
  v_and_b32 v3, 7, v3
  v_and_b32 v4, 7, v1
  v_xor_b32 v3, v3, v4
  v_lshlrev_b32 v3, 4, v3
  s_mov_b32 s47, 1280
  v_mad_u32_u24 v2, v2, s47, v3
  v_add_u32 v8, s36, v2
  v_add_u32 v9, 40960, v8
  v_add_u32 v10, 81920, v8
  v_add_u32 v11, 122880, v8
  v_add_u32 v12, 163840, v8
  v_add_u32 v13, 204800, v8
  v_add_u32 v14, 245760, v8
  v_add_u32 v15, 286720, v8
  v_lshrrev_b32 v2, 3, v1
  s_lshl_b32 s47, s43, 3
  v_add_u32 v2, s47, v2
  v_lshrrev_b32 v3, 4, v1
  v_and_b32 v3, 1, v3
  v_lshlrev_b32 v3, 2, v3
  v_and_b32 v4, 7, v1
  v_xor_b32 v3, v3, v4
  v_lshlrev_b32 v3, 4, v3
  s_mov_b32 s47, 3456
  v_mad_u32_u24 v2, v2, s47, v3
  v_add_u32 v16, s37, v2
  v_add_u32 v17, 110592, v16
  v_mov_b32 v18, v16
  v_mov_b32 v19, v17
  s_lshl_b32 s40, s43, 10
  s_mov_b32 s41, 0
  s_mov_b32 s42, 0
  s_mov_b32 s45, 0
  s_mov_b32 s44, 0
  s_waitcnt lgkmcnt(0)
  s_add_u32 s8, s6, 0x1400000
  s_addc_u32 s9, s7, 0
  s_mov_b32 s10, 0x280000
  s_mov_b32 s11, 0x00020000
  s_mov_b32 s12, s4
  s_mov_b32 s13, s5
  s_mov_b32 s14, 0x21c000
  s_mov_b32 s15, 0x00020000
  s_mov_b32 s16, s24
  s_mov_b32 s17, s25
  s_mov_b32 s18, 0x21c000
  s_mov_b32 s19, 0x00020000
  s_add_u32 s47, s40, 0
  s_add_u32 m0, s47, 0
  s_nop 0
  buffer_load_dwordx4 v8, s[8:11], s41 offen lds
  s_add_u32 m0, s47, 4096
  s_nop 0
  buffer_load_dwordx4 v9, s[8:11], s41 offen lds
  s_add_u32 m0, s47, 8192
  s_nop 0
  buffer_load_dwordx4 v10, s[8:11], s41 offen lds
  s_add_u32 m0, s47, 12288
  s_nop 0
  buffer_load_dwordx4 v11, s[8:11], s41 offen lds
  s_add_u32 m0, s47, 16384
  s_nop 0
  buffer_load_dwordx4 v12, s[8:11], s41 offen lds
  s_add_u32 m0, s47, 20480
  s_nop 0
  buffer_load_dwordx4 v13, s[8:11], s41 offen lds
  s_add_u32 m0, s47, 24576
  s_nop 0
  buffer_load_dwordx4 v14, s[8:11], s41 offen lds
  s_add_u32 m0, s47, 28672
  s_nop 0
  buffer_load_dwordx4 v15, s[8:11], s41 offen lds
  s_add_u32 m0, s47, 32768
  s_nop 0
  buffer_load_dwordx4 v16, s[12:15], s42 offen lds
  s_add_u32 m0, s47, 36864
  s_nop 0
  buffer_load_dwordx4 v17, s[12:15], s42 offen lds
  s_add_u32 m0, s47, 40960
  s_nop 0
  buffer_load_dwordx4 v18, s[16:19], s42 offen lds
  s_add_u32 m0, s47, 45056
  s_nop 0
  buffer_load_dwordx4 v19, s[16:19], s42 offen lds
  s_add_u32 s41, s41, 128
  s_add_u32 s42, s42, 221184
  s_add_u32 s47, s40, 49152
  s_add_u32 m0, s47, 0
  s_nop 0
  buffer_load_dwordx4 v8, s[8:11], s41 offen lds
  s_add_u32 m0, s47, 4096
  s_nop 0
  buffer_load_dwordx4 v9, s[8:11], s41 offen lds
  s_add_u32 m0, s47, 8192
  s_nop 0
  buffer_load_dwordx4 v10, s[8:11], s41 offen lds
  s_add_u32 m0, s47, 12288
  s_nop 0
  buffer_load_dwordx4 v11, s[8:11], s41 offen lds
  s_add_u32 m0, s47, 16384
  s_nop 0
  buffer_load_dwordx4 v12, s[8:11], s41 offen lds
  s_add_u32 m0, s47, 20480
  s_nop 0
  buffer_load_dwordx4 v13, s[8:11], s41 offen lds
  s_add_u32 m0, s47, 24576
  s_nop 0
  buffer_load_dwordx4 v14, s[8:11], s41 offen lds
  s_add_u32 m0, s47, 28672
  s_nop 0
  buffer_load_dwordx4 v15, s[8:11], s41 offen lds
  s_add_u32 m0, s47, 32768
  s_nop 0
  buffer_load_dwordx4 v16, s[12:15], s42 offen lds
  s_add_u32 m0, s47, 36864
  s_nop 0
  buffer_load_dwordx4 v17, s[12:15], s42 offen lds
  s_add_u32 m0, s47, 40960
  s_nop 0
  buffer_load_dwordx4 v18, s[16:19], s42 offen lds
  s_add_u32 m0, s47, 45056
  s_nop 0
  buffer_load_dwordx4 v19, s[16:19], s42 offen lds
  s_add_u32 s41, s41, 128
  s_add_u32 s42, s42, 221184
  s_waitcnt vmcnt(12)
  s_barrier
  s_add_u32 s47, s40, 98304
  s_add_u32 m0, s47, 0
  s_nop 0
  buffer_load_dwordx4 v8, s[8:11], s41 offen lds
  s_add_u32 m0, s47, 4096
  s_nop 0
  buffer_load_dwordx4 v9, s[8:11], s41 offen lds
  s_add_u32 m0, s47, 8192
  s_nop 0
  buffer_load_dwordx4 v10, s[8:11], s41 offen lds
  s_add_u32 m0, s47, 12288
  s_nop 0
  buffer_load_dwordx4 v11, s[8:11], s41 offen lds
  s_add_u32 m0, s47, 16384
  s_nop 0
  buffer_load_dwordx4 v12, s[8:11], s41 offen lds
  s_add_u32 m0, s47, 20480
  s_nop 0
  buffer_load_dwordx4 v13, s[8:11], s41 offen lds
  s_add_u32 m0, s47, 24576
  s_nop 0
  buffer_load_dwordx4 v14, s[8:11], s41 offen lds
  s_add_u32 m0, s47, 28672
  s_nop 0
  buffer_load_dwordx4 v15, s[8:11], s41 offen lds
  s_add_u32 m0, s47, 32768
  s_nop 0
  buffer_load_dwordx4 v16, s[12:15], s42 offen lds
  s_add_u32 m0, s47, 36864
  s_nop 0
  buffer_load_dwordx4 v17, s[12:15], s42 offen lds
  s_add_u32 m0, s47, 40960
  s_nop 0
  buffer_load_dwordx4 v18, s[16:19], s42 offen lds
  s_add_u32 m0, s47, 45056
  s_nop 0
  buffer_load_dwordx4 v19, s[16:19], s42 offen lds
  s_add_u32 s41, s41, 128
  s_add_u32 s42, s42, 221184
p4_ll_1:
  s_waitcnt vmcnt(12)
  s_barrier
  s_add_u32 s47, s40, s45
  s_add_u32 m0, s47, 0
  s_nop 0
  buffer_load_dwordx4 v8, s[8:11], s41 offen lds
  s_add_u32 m0, s47, 4096
  s_nop 0
  buffer_load_dwordx4 v9, s[8:11], s41 offen lds
  s_add_u32 m0, s47, 8192
  s_nop 0
  buffer_load_dwordx4 v10, s[8:11], s41 offen lds
  s_add_u32 m0, s47, 12288
  s_nop 0
  buffer_load_dwordx4 v11, s[8:11], s41 offen lds
  s_add_u32 m0, s47, 16384
  s_nop 0
  buffer_load_dwordx4 v12, s[8:11], s41 offen lds
  s_add_u32 m0, s47, 20480
  s_nop 0
  buffer_load_dwordx4 v13, s[8:11], s41 offen lds
  s_add_u32 m0, s47, 24576
  s_nop 0
  buffer_load_dwordx4 v14, s[8:11], s41 offen lds
  s_add_u32 m0, s47, 28672
  s_nop 0
  buffer_load_dwordx4 v15, s[8:11], s41 offen lds
  s_add_u32 m0, s47, 32768
  s_nop 0
  buffer_load_dwordx4 v16, s[12:15], s42 offen lds
  s_add_u32 m0, s47, 36864
  s_nop 0
  buffer_load_dwordx4 v17, s[12:15], s42 offen lds
  s_add_u32 m0, s47, 40960
  s_nop 0
  buffer_load_dwordx4 v18, s[16:19], s42 offen lds
  s_add_u32 m0, s47, 45056
  s_nop 0
  buffer_load_dwordx4 v19, s[16:19], s42 offen lds
  s_add_u32 s41, s41, 128
  s_add_u32 s42, s42, 221184
  s_add_u32 s45, s45, 49152
  s_cmp_eq_u32 s45, 147456
  s_cselect_b32 s45, 0, s45
  s_add_u32 s44, s44, 1
  s_cmp_lt_u32 s44, 7
  s_cbranch_scc1 p4_ll_1
  s_waitcnt vmcnt(12)
  s_barrier
  s_waitcnt vmcnt(0)
  s_barrier
  s_mov_b32 s20, s26
  s_mov_b32 s21, s27
  s_mov_b32 s22, 0x21c000
  s_mov_b32 s23, 0x00020000
  s_lshr_b32 s48, s2, 3
  s_lshl_b32 s48, s48, 2
  s_add_u32 s48, s48, s43
  s_mul_i32 s48, s48, 4096
  v_mul_u32_u24 v2, 64, v1
  buffer_load_dword v3, v2, s[20:23], s48 offen
  s_add_u32 s48, s48, 458752
  buffer_load_dword v4, v2, s[20:23], s48 offen
  s_add_u32 s48, s48, 458752
  buffer_load_dword v5, v2, s[20:23], s48 offen
  s_add_u32 s48, s48, 458752
  buffer_load_dword v6, v2, s[20:23], s48 offen
  s_add_u32 s48, s48, 458752
  buffer_load_dword v7, v2, s[20:23], s48 offen
  s_add_u32 s48, s48, 458752
  s_waitcnt vmcnt(0)
  s_endpgm
p4_comp:
  v_and_b32 v2, 31, v1
  s_lshl_b32 s47, s3, 5
  v_add_u32 v2, s47, v2
  v_lshrrev_b32 v3, 1, v2
  v_and_b32 v3, 7, v3
  v_lshrrev_b32 v4, 5, v1
  v_xor_b32 v3, v3, v4
  v_lshlrev_b32 v3, 4, v3
  v_lshl_add_u32 v152, v2, 7, v3
  v_xor_b32 v153, 32, v152
  v_xor_b32 v154, 64, v152
  v_xor_b32 v155, 96, v152
  v_lshlrev_b32 v2, 3, v4
  v_and_b32 v3, 15, v1
  v_lshrrev_b32 v3, 2, v3
  v_add_u32 v2, v2, v3
  v_mul_u32_u24 v2, 128, v2
  v_lshrrev_b32 v3, 4, v1
  v_and_b32 v3, 1, v3
  v_lshl_add_u32 v2, v3, 5, v2
  v_and_b32 v3, 3, v1
  v_lshl_add_u32 v2, v3, 3, v2
  v_lshrrev_b32 v3, 3, v1
  v_and_b32 v3, 1, v3
  v_lshl_add_u32 v2, v3, 6, v2
  v_add_u32 v156, 32768, v2
  v_xor_b32 v157, 64, v156
  s_mov_b32 s45, 0
  s_mov_b32 s44, 0
  v_mov_b32 v8, 0
  v_mov_b32 v9, 0
  v_mov_b32 v10, 0
  v_mov_b32 v11, 0
  v_mov_b32 v12, 0
  v_mov_b32 v13, 0
  v_mov_b32 v14, 0
  v_mov_b32 v15, 0
  v_mov_b32 v16, 0
  v_mov_b32 v17, 0
  v_mov_b32 v18, 0
  v_mov_b32 v19, 0
  v_mov_b32 v20, 0
  v_mov_b32 v21, 0
  v_mov_b32 v22, 0
  v_mov_b32 v23, 0
  v_mov_b32 v24, 0
  v_mov_b32 v25, 0
  v_mov_b32 v26, 0
  v_mov_b32 v27, 0
  v_mov_b32 v28, 0
  v_mov_b32 v29, 0
  v_mov_b32 v30, 0
  v_mov_b32 v31, 0
  v_mov_b32 v32, 0
  v_mov_b32 v33, 0
  v_mov_b32 v34, 0
  v_mov_b32 v35, 0
  v_mov_b32 v36, 0
  v_mov_b32 v37, 0
  v_mov_b32 v38, 0
  v_mov_b32 v39, 0
  v_mov_b32 v40, 0
  v_mov_b32 v41, 0
  v_mov_b32 v42, 0
  v_mov_b32 v43, 0
  v_mov_b32 v44, 0
  v_mov_b32 v45, 0
  v_mov_b32 v46, 0
  v_mov_b32 v47, 0
  v_mov_b32 v48, 0
  v_mov_b32 v49, 0
  v_mov_b32 v50, 0
  v_mov_b32 v51, 0
  v_mov_b32 v52, 0
  v_mov_b32 v53, 0
  v_mov_b32 v54, 0
  v_mov_b32 v55, 0
  v_mov_b32 v56, 0
  v_mov_b32 v57, 0
  v_mov_b32 v58, 0
  v_mov_b32 v59, 0
  v_mov_b32 v60, 0
  v_mov_b32 v61, 0
  v_mov_b32 v62, 0
  v_mov_b32 v63, 0
  v_mov_b32 v64, 0
  v_mov_b32 v65, 0
  v_mov_b32 v66, 0
  v_mov_b32 v67, 0
  v_mov_b32 v68, 0
  v_mov_b32 v69, 0
  v_mov_b32 v70, 0
  v_mov_b32 v71, 0
  v_and_b32 v2, 31, v1
  s_lshl_b32 s38, s61, 6
  v_add_u32 v3, s38, v2
  v_lshlrev_b32 v3, 4, v3
  s_lshl_b32 s59, s3, 5
  s_add_u32 s59, s59, s60
  v_add_u32 v2, s59, v2
  v_lshrrev_b32 v4, 5, v1
  v_mul_u32_u24 v5, 160, v2
  v_mul_u32_u24 v6, 80, v4
  v_add_u32 v5, v5, v6
  s_waitcnt lgkmcnt(0)
  s_add_u32 s20, s6, 0x8000
  s_addc_u32 s21, s7, 0
  s_mov_b32 s22, 0xd800
  s_mov_b32 s23, 0x00020000
  s_add_u32 s64, s6, 0x1700000
  s_addc_u32 s65, s7, 0
  s_mov_b32 s66, 0x50000
  s_mov_b32 s67, 0x00020000
  s_add_u32 s68, s6, 0x1800000
  s_addc_u32 s69, s7, 0
  s_mov_b32 s70, 0x6c0000
  s_mov_b32 s71, 0x00020000
  buffer_load_dwordx4 v[88:91], v5, s[64:67], 0 offen offset:0
  buffer_load_dwordx4 v[92:95], v5, s[64:67], 0 offen offset:16
  buffer_load_dwordx4 v[96:99], v5, s[64:67], 0 offen offset:32
  buffer_load_dwordx4 v[100:103], v5, s[64:67], 0 offen offset:48
  buffer_load_dwordx4 v[104:107], v5, s[64:67], 0 offen offset:64
  s_mov_b32 s38, 0
  buffer_load_dwordx4 v[72:75], v3, s[20:23], s38 offen
  s_mov_b32 s38, 512
  buffer_load_dwordx4 v[76:79], v3, s[20:23], s38 offen
  s_mov_b32 s38, 27648
  buffer_load_dwordx4 v[80:83], v3, s[20:23], s38 offen
  s_mov_b32 s38, 28160
  buffer_load_dwordx4 v[84:87], v3, s[20:23], s38 offen
  v_and_b32 v6, 31, v1
  s_lshl_b32 s47, s3, 5
  v_add_u32 v6, s47, v6
  v_lshrrev_b32 v7, 1, v6
  v_and_b32 v7, 7, v7
  v_lshlrev_b32 v7, 4, v7
  v_lshl_add_u32 v6, v6, 7, v7
  v_lshrrev_b32 v7, 5, v1
  v_lshl_add_u32 v6, v7, 3, v6
  v_add_u32 v165, 49152, v6
  s_waitcnt vmcnt(4)
  v_add_f32 v2, v88, v90
  v_add_f32 v2, v2, v92
  v_add_f32 v2, v2, v94
  v_add_f32 v2, v2, v96
  v_add_f32 v2, v2, v98
  v_add_f32 v2, v2, v100
  v_add_f32 v2, v2, v102
  v_add_f32 v2, v2, v104
  v_add_f32 v2, v2, v106
  v_mov_b32 v3, v2
  s_nop 1
  v_permlane32_swap_b32 v2, v3
  s_nop 1
  v_add_f32 v2, v2, v3
  v_mul_f32 v2, 0x3acccccd, v2
  v_mov_b32 v3, 0
  v_mul_f32 v4, 0x3d000000, v88
  v_sub_f32 v4, v4, v2
  v_mul_f32 v4, v4, v4
  v_add_f32 v3, v3, v89
  v_fmac_f32 v3, 0x42000000, v4
  v_mul_f32 v4, 0x3d000000, v90
  v_sub_f32 v4, v4, v2
  v_mul_f32 v4, v4, v4
  v_add_f32 v3, v3, v91
  v_fmac_f32 v3, 0x42000000, v4
  v_mul_f32 v4, 0x3d000000, v92
  v_sub_f32 v4, v4, v2
  v_mul_f32 v4, v4, v4
  v_add_f32 v3, v3, v93
  v_fmac_f32 v3, 0x42000000, v4
  v_mul_f32 v4, 0x3d000000, v94
  v_sub_f32 v4, v4, v2
  v_mul_f32 v4, v4, v4
  v_add_f32 v3, v3, v95
  v_fmac_f32 v3, 0x42000000, v4
  v_mul_f32 v4, 0x3d000000, v96
  v_sub_f32 v4, v4, v2
  v_mul_f32 v4, v4, v4
  v_add_f32 v3, v3, v97
  v_fmac_f32 v3, 0x42000000, v4
  v_mul_f32 v4, 0x3d000000, v98
  v_sub_f32 v4, v4, v2
  v_mul_f32 v4, v4, v4
  v_add_f32 v3, v3, v99
  v_fmac_f32 v3, 0x42000000, v4
  v_mul_f32 v4, 0x3d000000, v100
  v_sub_f32 v4, v4, v2
  v_mul_f32 v4, v4, v4
  v_add_f32 v3, v3, v101
  v_fmac_f32 v3, 0x42000000, v4
  v_mul_f32 v4, 0x3d000000, v102
  v_sub_f32 v4, v4, v2
  v_mul_f32 v4, v4, v4
  v_add_f32 v3, v3, v103
  v_fmac_f32 v3, 0x42000000, v4
  v_mul_f32 v4, 0x3d000000, v104
  v_sub_f32 v4, v4, v2
  v_mul_f32 v4, v4, v4
  v_add_f32 v3, v3, v105
  v_fmac_f32 v3, 0x42000000, v4
  v_mul_f32 v4, 0x3d000000, v106
  v_sub_f32 v4, v4, v2
  v_mul_f32 v4, v4, v4
  v_add_f32 v3, v3, v107
  v_fmac_f32 v3, 0x42000000, v4
  v_mov_b32 v4, v3
  s_nop 1
  v_permlane32_swap_b32 v3, v4
  s_nop 1
  v_add_f32 v3, v3, v4
  v_mov_b32 v164, 0x3727c5ac
  v_fmac_f32 v164, 0x3acccccd, v3
  v_sqrt_f32 v5, v164
  v_rsq_f32 v6, v164
  s_nop 0
  v_sub_f32 v2, 0, v2
  v_and_b32 v7, 0xffff0000, v2
  v_sub_f32 v2, v2, v7
  v_cvt_pk_bf16_f32 v158, v7, v7
  v_cvt_pk_bf16_f32 v159, v2, v2
  v_and_b32 v7, 0xffff0000, v5
  v_sub_f32 v5, v5, v7
  v_cvt_pk_bf16_f32 v160, v7, v7
  v_cvt_pk_bf16_f32 v161, v5, v5
  v_cmp_gt_u32 vcc, 32, v1
  v_cndmask_b32 v158, 0, v158, vcc
  v_cndmask_b32 v159, 0, v159, vcc
  v_cndmask_b32 v160, 0, v160, vcc
  v_cndmask_b32 v161, 0, v161, vcc
  v_mul_f32 v162, 0xc0135761, v6
  v_mul_f32 v7, v6, v6
  v_mul_f32 v7, v7, v6
  v_mul_f32 v163, 0xbdd2d3e8, v7
  s_waitcnt vmcnt(0)
  v_mfma_f32_32x32x16_bf16 v[8:23], v[72:75], v[158:161], v[8:23]
  v_mfma_f32_32x32x16_bf16 v[24:39], v[76:79], v[158:161], v[24:39]
  v_mfma_f32_32x32x16_bf16 v[40:55], v[80:83], v[158:161], v[40:55]
  v_mfma_f32_32x32x16_bf16 v[56:71], v[84:87], v[158:161], v[56:71]
  s_barrier
  ds_read_b128 v[72:75], v152
  ds_read_b64_tr_b16 v[88:89], v156 offset:0
  ds_read_b64_tr_b16 v[90:91], v156 offset:512
  ds_read_b64_tr_b16 v[92:93], v157 offset:0
  ds_read_b64_tr_b16 v[94:95], v157 offset:512
  ds_read_b64_tr_b16 v[96:97], v156 offset:8192
  ds_read_b64_tr_b16 v[98:99], v156 offset:8704
  ds_read_b64_tr_b16 v[100:101], v157 offset:8192
  ds_read_b64_tr_b16 v[102:103], v157 offset:8704
  ds_read_b128 v[76:79], v153
  ds_read_b64_tr_b16 v[104:105], v156 offset:2048
  ds_read_b64_tr_b16 v[106:107], v156 offset:2560
  ds_read_b64_tr_b16 v[108:109], v157 offset:2048
  ds_read_b64_tr_b16 v[110:111], v157 offset:2560
  ds_read_b64_tr_b16 v[112:113], v156 offset:10240
  ds_read_b64_tr_b16 v[114:115], v156 offset:10752
  ds_read_b64_tr_b16 v[116:117], v157 offset:10240
  ds_read_b64_tr_b16 v[118:119], v157 offset:10752
p4_loop_2:
  s_waitcnt lgkmcnt(9)
  v_mfma_f32_32x32x16_bf16 v[8:23], v[88:91], v[72:75], v[8:23]
  ds_read_b128 v[80:83], v154
  ds_read_b64_tr_b16 v[120:121], v156 offset:4096
  ds_read_b64_tr_b16 v[122:123], v156 offset:4608
  v_mfma_f32_32x32x16_bf16 v[24:39], v[92:95], v[72:75], v[24:39]
  ds_read_b64_tr_b16 v[124:125], v157 offset:4096
  ds_read_b64_tr_b16 v[126:127], v157 offset:4608
  v_mfma_f32_32x32x16_bf16 v[40:55], v[96:99], v[72:75], v[40:55]
  ds_read_b64_tr_b16 v[128:129], v156 offset:12288
  ds_read_b64_tr_b16 v[130:131], v156 offset:12800
  v_mfma_f32_32x32x16_bf16 v[56:71], v[100:103], v[72:75], v[56:71]
  ds_read_b64_tr_b16 v[132:133], v157 offset:12288
  ds_read_b64_tr_b16 v[134:135], v157 offset:12800
  s_waitcnt lgkmcnt(9)
  v_mfma_f32_32x32x16_bf16 v[8:23], v[104:107], v[76:79], v[8:23]
  ds_read_b128 v[84:87], v155
  ds_read_b64_tr_b16 v[136:137], v156 offset:6144
  ds_read_b64_tr_b16 v[138:139], v156 offset:6656
  ds_read_b64_tr_b16 v[140:141], v157 offset:6144
  ds_read_b64_tr_b16 v[142:143], v157 offset:6656
  v_mfma_f32_32x32x16_bf16 v[24:39], v[108:111], v[76:79], v[24:39]
  ds_read_b64_tr_b16 v[144:145], v156 offset:14336
  ds_read_b64_tr_b16 v[146:147], v156 offset:14848
  ds_read_b64_tr_b16 v[148:149], v157 offset:14336
  ds_read_b64_tr_b16 v[150:151], v157 offset:14848
  v_mfma_f32_32x32x16_bf16 v[40:55], v[112:115], v[76:79], v[40:55]
  v_mfma_f32_32x32x16_bf16 v[56:71], v[116:119], v[76:79], v[56:71]
  s_waitcnt lgkmcnt(0)
  s_barrier
  s_add_u32 s46, s45, 49152
  s_cmp_eq_u32 s46, 147456
  s_cselect_b32 s46, 0, s46
  s_sub_u32 s47, s46, s45
  s_mov_b32 s45, s46
  v_mfma_f32_32x32x16_bf16 v[8:23], v[120:123], v[80:83], v[8:23]
  v_add_u32 v152, s47, v152
  v_add_u32 v153, s47, v153
  v_add_u32 v154, s47, v154
  v_add_u32 v155, s47, v155
  v_add_u32 v156, s47, v156
  v_add_u32 v157, s47, v157
  ds_read_b128 v[72:75], v152
  ds_read_b64_tr_b16 v[88:89], v156 offset:0
  ds_read_b64_tr_b16 v[90:91], v156 offset:512
  v_mfma_f32_32x32x16_bf16 v[24:39], v[124:127], v[80:83], v[24:39]
  ds_read_b64_tr_b16 v[92:93], v157 offset:0
  ds_read_b64_tr_b16 v[94:95], v157 offset:512
  v_mfma_f32_32x32x16_bf16 v[40:55], v[128:131], v[80:83], v[40:55]
  ds_read_b64_tr_b16 v[96:97], v156 offset:8192
  ds_read_b64_tr_b16 v[98:99], v156 offset:8704
  v_mfma_f32_32x32x16_bf16 v[56:71], v[132:135], v[80:83], v[56:71]
  ds_read_b64_tr_b16 v[100:101], v157 offset:8192
  ds_read_b64_tr_b16 v[102:103], v157 offset:8704
  s_waitcnt lgkmcnt(9)
  v_mfma_f32_32x32x16_bf16 v[8:23], v[136:139], v[84:87], v[8:23]
  ds_read_b128 v[76:79], v153
  ds_read_b64_tr_b16 v[104:105], v156 offset:2048
  ds_read_b64_tr_b16 v[106:107], v156 offset:2560
  v_mfma_f32_32x32x16_bf16 v[24:39], v[140:143], v[84:87], v[24:39]
  ds_read_b64_tr_b16 v[108:109], v157 offset:2048
  ds_read_b64_tr_b16 v[110:111], v157 offset:2560
  v_mfma_f32_32x32x16_bf16 v[40:55], v[144:147], v[84:87], v[40:55]
  ds_read_b64_tr_b16 v[112:113], v156 offset:10240
  ds_read_b64_tr_b16 v[114:115], v156 offset:10752
  v_mfma_f32_32x32x16_bf16 v[56:71], v[148:151], v[84:87], v[56:71]
  ds_read_b64_tr_b16 v[116:117], v157 offset:10240
  ds_read_b64_tr_b16 v[118:119], v157 offset:10752
  s_add_u32 s44, s44, 1
  s_cmp_lt_u32 s44, 9
  s_cbranch_scc1 p4_loop_2
  s_waitcnt lgkmcnt(9)
  v_mfma_f32_32x32x16_bf16 v[8:23], v[88:91], v[72:75], v[8:23]
  ds_read_b128 v[80:83], v154
  ds_read_b64_tr_b16 v[120:121], v156 offset:4096
  ds_read_b64_tr_b16 v[122:123], v156 offset:4608
  v_mfma_f32_32x32x16_bf16 v[24:39], v[92:95], v[72:75], v[24:39]
  ds_read_b64_tr_b16 v[124:125], v157 offset:4096
  ds_read_b64_tr_b16 v[126:127], v157 offset:4608
  v_mfma_f32_32x32x16_bf16 v[40:55], v[96:99], v[72:75], v[40:55]
  ds_read_b64_tr_b16 v[128:129], v156 offset:12288
  ds_read_b64_tr_b16 v[130:131], v156 offset:12800
  v_mfma_f32_32x32x16_bf16 v[56:71], v[100:103], v[72:75], v[56:71]
  ds_read_b64_tr_b16 v[132:133], v157 offset:12288
  ds_read_b64_tr_b16 v[134:135], v157 offset:12800
  s_waitcnt lgkmcnt(9)
  v_mfma_f32_32x32x16_bf16 v[8:23], v[104:107], v[76:79], v[8:23]
  ds_read_b128 v[84:87], v155
  ds_read_b64_tr_b16 v[136:137], v156 offset:6144
  ds_read_b64_tr_b16 v[138:139], v156 offset:6656
  ds_read_b64_tr_b16 v[140:141], v157 offset:6144
  ds_read_b64_tr_b16 v[142:143], v157 offset:6656
  v_mfma_f32_32x32x16_bf16 v[24:39], v[108:111], v[76:79], v[24:39]
  ds_read_b64_tr_b16 v[144:145], v156 offset:14336
  ds_read_b64_tr_b16 v[146:147], v156 offset:14848
  ds_read_b64_tr_b16 v[148:149], v157 offset:14336
  ds_read_b64_tr_b16 v[150:151], v157 offset:14848
  v_mfma_f32_32x32x16_bf16 v[40:55], v[112:115], v[76:79], v[40:55]
  v_mfma_f32_32x32x16_bf16 v[56:71], v[116:119], v[76:79], v[56:71]
  s_waitcnt lgkmcnt(9)
  v_mfma_f32_32x32x16_bf16 v[8:23], v[120:123], v[80:83], v[8:23]
  v_mfma_f32_32x32x16_bf16 v[24:39], v[124:127], v[80:83], v[24:39]
  v_mfma_f32_32x32x16_bf16 v[40:55], v[128:131], v[80:83], v[40:55]
  v_mfma_f32_32x32x16_bf16 v[56:71], v[132:135], v[80:83], v[56:71]
  s_waitcnt lgkmcnt(0)
  v_mfma_f32_32x32x16_bf16 v[8:23], v[136:139], v[84:87], v[8:23]
  v_mfma_f32_32x32x16_bf16 v[24:39], v[140:143], v[84:87], v[24:39]
  v_mfma_f32_32x32x16_bf16 v[40:55], v[144:147], v[84:87], v[40:55]
  v_mfma_f32_32x32x16_bf16 v[56:71], v[148:151], v[84:87], v[56:71]
  s_nop 15
  s_lshl_b32 s47, s3, 5
  s_add_u32 s47, s47, s60
  v_lshrrev_b32 v4, 3, v1
  v_add_u32 v4, s47, v4
  s_movk_i32 s47, 3456
  v_mul_lo_u32 v4, v4, s47
  v_lshrrev_b32 v5, 4, v1
  v_xor_b32 v5, v5, v1
  v_and_b32 v5, 7, v5
  v_lshl_add_u32 v4, v5, 4, v4
  v_add_u32 v2, s37, v4
  v_xor_b32 v3, 64, v2
  v_mov_b32 v112, v162
  v_mov_b32 v113, v162
  v_mov_b32 v114, v163
  v_mov_b32 v115, v163
  v_mov_b32 v116, v164
  v_mov_b32 v117, v164
  v_xor_b32 v104, 0, v165
  v_xor_b32 v105, 16, v165
  v_xor_b32 v106, 32, v165
  v_xor_b32 v107, 48, v165
  v_xor_b32 v108, 64, v165
  v_xor_b32 v109, 80, v165
  v_xor_b32 v110, 96, v165
  v_xor_b32 v111, 112, v165
  v_pk_mul_f32 v[72:73], v[8:9], v[8:9]
  v_pk_mul_f32 v[74:75], v[10:11], v[10:11]
  v_pk_mul_f32 v[76:77], v[12:13], v[12:13]
  v_pk_mul_f32 v[78:79], v[14:15], v[14:15]
  v_pk_fma_f32 v[72:73], v[72:73], v[114:115], v[112:113]
  v_pk_fma_f32 v[74:75], v[74:75], v[114:115], v[112:113]
  v_pk_fma_f32 v[76:77], v[76:77], v[114:115], v[112:113]
  v_pk_fma_f32 v[78:79], v[78:79], v[114:115], v[112:113]
  v_pk_mul_f32 v[72:73], v[72:73], v[8:9]
  v_pk_mul_f32 v[74:75], v[74:75], v[10:11]
  v_pk_mul_f32 v[76:77], v[76:77], v[12:13]
  v_pk_mul_f32 v[78:79], v[78:79], v[14:15]
  v_exp_f32 v72, v72
  v_exp_f32 v73, v73
  v_exp_f32 v74, v74
  v_exp_f32 v75, v75
  v_exp_f32 v76, v76
  v_exp_f32 v77, v77
  v_exp_f32 v78, v78
  v_exp_f32 v79, v79
  v_pk_mul_f32 v[80:81], v[8:9], v[40:41]
  v_pk_mul_f32 v[82:83], v[10:11], v[42:43]
  v_pk_mul_f32 v[84:85], v[12:13], v[44:45]
  v_pk_mul_f32 v[86:87], v[14:15], v[46:47]
  v_pk_fma_f32 v[72:73], v[72:73], v[116:117], v[116:117]
  v_pk_fma_f32 v[74:75], v[74:75], v[116:117], v[116:117]
  v_pk_fma_f32 v[76:77], v[76:77], v[116:117], v[116:117]
  v_pk_fma_f32 v[78:79], v[78:79], v[116:117], v[116:117]
  v_rcp_f32 v72, v72
  v_rcp_f32 v73, v73
  v_rcp_f32 v74, v74
  v_rcp_f32 v75, v75
  v_rcp_f32 v76, v76
  v_rcp_f32 v77, v77
  v_rcp_f32 v78, v78
  v_rcp_f32 v79, v79
  s_nop 0
  v_pk_mul_f32 v[80:81], v[80:81], v[72:73]
  v_pk_mul_f32 v[82:83], v[82:83], v[74:75]
  v_pk_mul_f32 v[84:85], v[84:85], v[76:77]
  v_pk_mul_f32 v[86:87], v[86:87], v[78:79]
  v_cvt_pk_bf16_f32 v88, v80, v81
  v_cvt_pk_bf16_f32 v89, v82, v83
  ds_write_b64 v104, v[88:89]
  v_cvt_pk_bf16_f32 v90, v84, v85
  v_cvt_pk_bf16_f32 v91, v86, v87
  ds_write_b64 v105, v[90:91]
  v_pk_mul_f32 v[72:73], v[16:17], v[16:17]
  v_pk_mul_f32 v[74:75], v[18:19], v[18:19]
  v_pk_mul_f32 v[76:77], v[20:21], v[20:21]
  v_pk_mul_f32 v[78:79], v[22:23], v[22:23]
  v_pk_fma_f32 v[72:73], v[72:73], v[114:115], v[112:113]
  v_pk_fma_f32 v[74:75], v[74:75], v[114:115], v[112:113]
  v_pk_fma_f32 v[76:77], v[76:77], v[114:115], v[112:113]
  v_pk_fma_f32 v[78:79], v[78:79], v[114:115], v[112:113]
  v_pk_mul_f32 v[72:73], v[72:73], v[16:17]
  v_pk_mul_f32 v[74:75], v[74:75], v[18:19]
  v_pk_mul_f32 v[76:77], v[76:77], v[20:21]
  v_pk_mul_f32 v[78:79], v[78:79], v[22:23]
  v_exp_f32 v72, v72
  v_exp_f32 v73, v73
  v_exp_f32 v74, v74
  v_exp_f32 v75, v75
  v_exp_f32 v76, v76
  v_exp_f32 v77, v77
  v_exp_f32 v78, v78
  v_exp_f32 v79, v79
  v_pk_mul_f32 v[80:81], v[16:17], v[48:49]
  v_pk_mul_f32 v[82:83], v[18:19], v[50:51]
  v_pk_mul_f32 v[84:85], v[20:21], v[52:53]
  v_pk_mul_f32 v[86:87], v[22:23], v[54:55]
  v_pk_fma_f32 v[72:73], v[72:73], v[116:117], v[116:117]
  v_pk_fma_f32 v[74:75], v[74:75], v[116:117], v[116:117]
  v_pk_fma_f32 v[76:77], v[76:77], v[116:117], v[116:117]
  v_pk_fma_f32 v[78:79], v[78:79], v[116:117], v[116:117]
  v_rcp_f32 v72, v72
  v_rcp_f32 v73, v73
  v_rcp_f32 v74, v74
  v_rcp_f32 v75, v75
  v_rcp_f32 v76, v76
  v_rcp_f32 v77, v77
  v_rcp_f32 v78, v78
  v_rcp_f32 v79, v79
  s_nop 0
  v_pk_mul_f32 v[80:81], v[80:81], v[72:73]
  v_pk_mul_f32 v[82:83], v[82:83], v[74:75]
  v_pk_mul_f32 v[84:85], v[84:85], v[76:77]
  v_pk_mul_f32 v[86:87], v[86:87], v[78:79]
  v_cvt_pk_bf16_f32 v92, v80, v81
  v_cvt_pk_bf16_f32 v93, v82, v83
  ds_write_b64 v106, v[92:93]
  v_cvt_pk_bf16_f32 v94, v84, v85
  v_cvt_pk_bf16_f32 v95, v86, v87
  ds_write_b64 v107, v[94:95]
  v_pk_mul_f32 v[72:73], v[24:25], v[24:25]
  v_pk_mul_f32 v[74:75], v[26:27], v[26:27]
  v_pk_mul_f32 v[76:77], v[28:29], v[28:29]
  v_pk_mul_f32 v[78:79], v[30:31], v[30:31]
  v_pk_fma_f32 v[72:73], v[72:73], v[114:115], v[112:113]
  v_pk_fma_f32 v[74:75], v[74:75], v[114:115], v[112:113]
  v_pk_fma_f32 v[76:77], v[76:77], v[114:115], v[112:113]
  v_pk_fma_f32 v[78:79], v[78:79], v[114:115], v[112:113]
  v_pk_mul_f32 v[72:73], v[72:73], v[24:25]
  v_pk_mul_f32 v[74:75], v[74:75], v[26:27]
  v_pk_mul_f32 v[76:77], v[76:77], v[28:29]
  v_pk_mul_f32 v[78:79], v[78:79], v[30:31]
  v_exp_f32 v72, v72
  v_exp_f32 v73, v73
  v_exp_f32 v74, v74
  v_exp_f32 v75, v75
  v_exp_f32 v76, v76
  v_exp_f32 v77, v77
  v_exp_f32 v78, v78
  v_exp_f32 v79, v79
  v_pk_mul_f32 v[80:81], v[24:25], v[56:57]
  v_pk_mul_f32 v[82:83], v[26:27], v[58:59]
  v_pk_mul_f32 v[84:85], v[28:29], v[60:61]
  v_pk_mul_f32 v[86:87], v[30:31], v[62:63]
  v_pk_fma_f32 v[72:73], v[72:73], v[116:117], v[116:117]
  v_pk_fma_f32 v[74:75], v[74:75], v[116:117], v[116:117]
  v_pk_fma_f32 v[76:77], v[76:77], v[116:117], v[116:117]
  v_pk_fma_f32 v[78:79], v[78:79], v[116:117], v[116:117]
  v_rcp_f32 v72, v72
  v_rcp_f32 v73, v73
  v_rcp_f32 v74, v74
  v_rcp_f32 v75, v75
  v_rcp_f32 v76, v76
  v_rcp_f32 v77, v77
  v_rcp_f32 v78, v78
  v_rcp_f32 v79, v79
  s_nop 0
  v_pk_mul_f32 v[80:81], v[80:81], v[72:73]
  v_pk_mul_f32 v[82:83], v[82:83], v[74:75]
  v_pk_mul_f32 v[84:85], v[84:85], v[76:77]
  v_pk_mul_f32 v[86:87], v[86:87], v[78:79]
  v_cvt_pk_bf16_f32 v96, v80, v81
  v_cvt_pk_bf16_f32 v97, v82, v83
  ds_write_b64 v108, v[96:97]
  v_cvt_pk_bf16_f32 v98, v84, v85
  v_cvt_pk_bf16_f32 v99, v86, v87
  ds_write_b64 v109, v[98:99]
  v_pk_mul_f32 v[72:73], v[32:33], v[32:33]
  v_pk_mul_f32 v[74:75], v[34:35], v[34:35]
  v_pk_mul_f32 v[76:77], v[36:37], v[36:37]
  v_pk_mul_f32 v[78:79], v[38:39], v[38:39]
  v_pk_fma_f32 v[72:73], v[72:73], v[114:115], v[112:113]
  v_pk_fma_f32 v[74:75], v[74:75], v[114:115], v[112:113]
  v_pk_fma_f32 v[76:77], v[76:77], v[114:115], v[112:113]
  v_pk_fma_f32 v[78:79], v[78:79], v[114:115], v[112:113]
  v_pk_mul_f32 v[72:73], v[72:73], v[32:33]
  v_pk_mul_f32 v[74:75], v[74:75], v[34:35]
  v_pk_mul_f32 v[76:77], v[76:77], v[36:37]
  v_pk_mul_f32 v[78:79], v[78:79], v[38:39]
  v_exp_f32 v72, v72
  v_exp_f32 v73, v73
  v_exp_f32 v74, v74
  v_exp_f32 v75, v75
  v_exp_f32 v76, v76
  v_exp_f32 v77, v77
  v_exp_f32 v78, v78
  v_exp_f32 v79, v79
  v_pk_mul_f32 v[80:81], v[32:33], v[64:65]
  v_pk_mul_f32 v[82:83], v[34:35], v[66:67]
  v_pk_mul_f32 v[84:85], v[36:37], v[68:69]
  v_pk_mul_f32 v[86:87], v[38:39], v[70:71]
  v_pk_fma_f32 v[72:73], v[72:73], v[116:117], v[116:117]
  v_pk_fma_f32 v[74:75], v[74:75], v[116:117], v[116:117]
  v_pk_fma_f32 v[76:77], v[76:77], v[116:117], v[116:117]
  v_pk_fma_f32 v[78:79], v[78:79], v[116:117], v[116:117]
  v_rcp_f32 v72, v72
  v_rcp_f32 v73, v73
  v_rcp_f32 v74, v74
  v_rcp_f32 v75, v75
  v_rcp_f32 v76, v76
  v_rcp_f32 v77, v77
  v_rcp_f32 v78, v78
  v_rcp_f32 v79, v79
  s_nop 0
  v_pk_mul_f32 v[80:81], v[80:81], v[72:73]
  v_pk_mul_f32 v[82:83], v[82:83], v[74:75]
  v_pk_mul_f32 v[84:85], v[84:85], v[76:77]
  v_pk_mul_f32 v[86:87], v[86:87], v[78:79]
  v_cvt_pk_bf16_f32 v100, v80, v81
  v_cvt_pk_bf16_f32 v101, v82, v83
  ds_write_b64 v110, v[100:101]
  v_cvt_pk_bf16_f32 v102, v84, v85
  v_cvt_pk_bf16_f32 v103, v86, v87
  ds_write_b64 v111, v[102:103]
  s_lshl_b32 s48, s3, 12
  s_add_u32 s48, s48, 49152
  v_lshlrev_b32 v4, 4, v1
  v_add_u32 v4, s48, v4
  s_waitcnt lgkmcnt(0)
  ds_read_b128 v[8:11], v4 offset:0
  ds_read_b128 v[12:15], v4 offset:1024
  ds_read_b128 v[16:19], v4 offset:2048
  ds_read_b128 v[20:23], v4 offset:3072
  s_mov_b32 s49, 0
  s_waitcnt lgkmcnt(3)
  buffer_store_dwordx4 v[8:11], v2, s[68:71], s49 offen
  s_mov_b32 s49, 27648
  s_waitcnt lgkmcnt(2)
  buffer_store_dwordx4 v[12:15], v3, s[68:71], s49 offen
  s_mov_b32 s49, 55296
  s_waitcnt lgkmcnt(1)
  buffer_store_dwordx4 v[16:19], v2, s[68:71], s49 offen
  s_mov_b32 s49, 82944
  s_waitcnt lgkmcnt(0)
  buffer_store_dwordx4 v[20:23], v3, s[68:71], s49 offen
p4_END:
  s_endpgm
.section .rodata,"a"
.p2align 6
.amdhsa_kernel p4_kernel
  .amdhsa_next_free_vgpr 166
  .amdhsa_next_free_sgpr 102
  .amdhsa_accum_offset 168
  .amdhsa_group_segment_fixed_size 0
  .amdhsa_kernarg_size 96
  .amdhsa_user_sgpr_count 2
  .amdhsa_user_sgpr_kernarg_segment_ptr 1
  .amdhsa_system_sgpr_workgroup_id_x 1
.end_amdhsa_kernel
.text
.globl p5_kernel
.p2align 8
.type p5_kernel,@function
p5_kernel:
  s_cmp_ge_u32 s2, 224
  s_cbranch_scc1 p5_END
  s_load_dwordx2 s[4:5], s[0:1], 48
  s_load_dwordx2 s[6:7], s[0:1], 88
  s_load_dwordx2 s[24:25], s[0:1], 72
  v_lshrrev_b32 v1, 6, v0
  s_nop 0
  v_readfirstlane_b32 s3, v1
  v_and_b32 v1, 63, v0
  s_nop 3
  s_and_b32 s33, s2, 7
  s_mul_i32 s33, s33, 28
  s_lshr_b32 s34, s2, 3
  s_cmp_ge_u32 s34, 28
  s_cbranch_scc1 p5_END
  s_add_u32 s33, s33, s34
  s_cmp_ge_u32 s33, 220
  s_cbranch_scc1 p5_END
  s_mul_i32 s34, s33, 6554
  s_lshr_b32 s34, s34, 16
  s_mul_i32 s35, s34, 10
  s_sub_u32 s61, s33, s35
  s_mul_i32 s34, s34, 96
  s_min_u32 s60, s34, 1952
  s_lshl_b32 s37, s61, 7
  s_cmp_lt_u32 s3, 3
  s_cbranch_scc1 p5_comp
  s_mul_i32 s36, s60, 3456
  s_sub_u32 s43, s3, 3
  v_lshrrev_b32 v2, 3, v1
  s_lshl_b32 s47, s43, 3
  v_add_u32 v2, s47, v2
  v_lshrrev_b32 v3, 1, v2
  v_and_b32 v3, 7, v3
  v_and_b32 v4, 7, v1
  v_xor_b32 v3, v3, v4
  v_lshlrev_b32 v3, 4, v3
  s_mov_b32 s47, 3456
  v_mad_u32_u24 v2, v2, s47, v3
  v_add_u32 v8, s36, v2
  v_add_u32 v9, 110592, v8
  v_add_u32 v10, 221184, v8
  v_lshrrev_b32 v2, 3, v1
  s_lshl_b32 s47, s43, 3
  v_add_u32 v2, s47, v2
  v_lshrrev_b32 v3, 4, v1
  v_and_b32 v3, 1, v3
  v_lshlrev_b32 v3, 2, v3
  v_and_b32 v4, 7, v1
  v_xor_b32 v3, v3, v4
  v_lshlrev_b32 v3, 4, v3
  s_mov_b32 s47, 1280
  v_mad_u32_u24 v2, v2, s47, v3
  v_add_u32 v11, s37, v2
  v_add_u32 v12, 40960, v11
  s_lshl_b32 s40, s43, 10
  s_mov_b32 s41, 0
  s_mov_b32 s42, 0
  s_mov_b32 s45, 0
  s_mov_b32 s44, 0
  s_waitcnt lgkmcnt(0)
  s_add_u32 s8, s6, 0x1800000
  s_addc_u32 s9, s7, 0
  s_mov_b32 s10, 0x6c0000
  s_mov_b32 s11, 0x00020000
  s_mov_b32 s12, s4
  s_mov_b32 s13, s5
  s_mov_b32 s14, 0x21c000
  s_mov_b32 s15, 0x00020000
  s_add_u32 s47, s40, 0
  s_add_u32 m0, s47, 0
  s_nop 0
  buffer_load_dwordx4 v8, s[8:11], s41 offen lds
  s_add_u32 m0, s47, 4096
  s_nop 0
  buffer_load_dwordx4 v9, s[8:11], s41 offen lds
  s_add_u32 m0, s47, 8192
  s_nop 0
  buffer_load_dwordx4 v10, s[8:11], s41 offen lds
  s_add_u32 m0, s47, 12288
  s_nop 0
  buffer_load_dwordx4 v11, s[12:15], s42 offen lds
  s_add_u32 m0, s47, 16384
  s_nop 0
  buffer_load_dwordx4 v12, s[12:15], s42 offen lds
  s_add_u32 s41, s41, 128
  s_add_u32 s42, s42, 81920
  s_add_u32 s47, s40, 20480
  s_add_u32 m0, s47, 0
  s_nop 0
  buffer_load_dwordx4 v8, s[8:11], s41 offen lds
  s_add_u32 m0, s47, 4096
  s_nop 0
  buffer_load_dwordx4 v9, s[8:11], s41 offen lds
  s_add_u32 m0, s47, 8192
  s_nop 0
  buffer_load_dwordx4 v10, s[8:11], s41 offen lds
  s_add_u32 m0, s47, 12288
  s_nop 0
  buffer_load_dwordx4 v11, s[12:15], s42 offen lds
  s_add_u32 m0, s47, 16384
  s_nop 0
  buffer_load_dwordx4 v12, s[12:15], s42 offen lds
  s_add_u32 s41, s41, 128
  s_add_u32 s42, s42, 81920
  s_add_u32 s47, s40, 40960
  s_add_u32 m0, s47, 0
  s_nop 0
  buffer_load_dwordx4 v8, s[8:11], s41 offen lds
  s_add_u32 m0, s47, 4096
  s_nop 0
  buffer_load_dwordx4 v9, s[8:11], s41 offen lds
  s_add_u32 m0, s47, 8192
  s_nop 0
  buffer_load_dwordx4 v10, s[8:11], s41 offen lds
  s_add_u32 m0, s47, 12288
  s_nop 0
  buffer_load_dwordx4 v11, s[12:15], s42 offen lds
  s_add_u32 m0, s47, 16384
  s_nop 0
  buffer_load_dwordx4 v12, s[12:15], s42 offen lds
  s_add_u32 s41, s41, 128
  s_add_u32 s42, s42, 81920
  s_waitcnt vmcnt(10)
  s_barrier
  s_add_u32 s47, s40, 61440
  s_add_u32 m0, s47, 0
  s_nop 0
  buffer_load_dwordx4 v8, s[8:11], s41 offen lds
  s_add_u32 m0, s47, 4096
  s_nop 0
  buffer_load_dwordx4 v9, s[8:11], s41 offen lds
  s_add_u32 m0, s47, 8192
  s_nop 0
  buffer_load_dwordx4 v10, s[8:11], s41 offen lds
  s_add_u32 m0, s47, 12288
  s_nop 0
  buffer_load_dwordx4 v11, s[12:15], s42 offen lds
  s_add_u32 m0, s47, 16384
  s_nop 0
  buffer_load_dwordx4 v12, s[12:15], s42 offen lds
  s_add_u32 s41, s41, 128
  s_add_u32 s42, s42, 81920
  s_mov_b32 s45, 81920
p5_ll_1:
  s_waitcnt vmcnt(10)
  s_barrier
  s_add_u32 s47, s40, s45
  s_add_u32 m0, s47, 0
  s_nop 0
  buffer_load_dwordx4 v8, s[8:11], s41 offen lds
  s_add_u32 m0, s47, 4096
  s_nop 0
  buffer_load_dwordx4 v9, s[8:11], s41 offen lds
  s_add_u32 m0, s47, 8192
  s_nop 0
  buffer_load_dwordx4 v10, s[8:11], s41 offen lds
  s_add_u32 m0, s47, 12288
  s_nop 0
  buffer_load_dwordx4 v11, s[12:15], s42 offen lds
  s_add_u32 m0, s47, 16384
  s_nop 0
  buffer_load_dwordx4 v12, s[12:15], s42 offen lds
  s_add_u32 s41, s41, 128
  s_add_u32 s42, s42, 81920
  s_add_u32 s45, s45, 20480
  s_cmp_eq_u32 s45, 102400
  s_cselect_b32 s45, 0, s45
  s_add_u32 s44, s44, 1
  s_cmp_lt_u32 s44, 23
  s_cbranch_scc1 p5_ll_1
  s_waitcnt vmcnt(10)
  s_barrier
  s_waitcnt vmcnt(5)
  s_barrier
  s_waitcnt vmcnt(0)
  s_barrier
  s_endpgm
p5_comp:
  s_lshl_b32 s47, s3, 5
  s_add_u32 s47, s47, s60
  v_lshrrev_b32 v2, 3, v1
  v_add_u32 v2, s47, v2
  s_movk_i32 s47, 1280
  v_mul_lo_u32 v2, v2, s47
  v_lshrrev_b32 v3, 4, v1
  v_xor_b32 v3, v3, v1
  v_and_b32 v3, 7, v3
  v_lshl_add_u32 v2, v3, 4, v2
  v_add_u32 v146, s37, v2
  v_xor_b32 v147, 64, v146
  v_lshrrev_b32 v3, 5, v1
  v_lshlrev_b32 v145, 4, v3
  s_lshl_b32 s38, s61, 8
  v_add_u32 v145, s38, v145
  v_and_b32 v2, 31, v1
  s_lshl_b32 s47, s3, 5
  v_add_u32 v2, s47, v2
  v_lshrrev_b32 v3, 1, v2
  v_and_b32 v3, 7, v3
  v_lshrrev_b32 v4, 5, v1
  v_xor_b32 v3, v3, v4
  v_lshlrev_b32 v3, 4, v3
  v_lshl_add_u32 v88, v2, 7, v3
  v_xor_b32 v89, 32, v88
  v_xor_b32 v90, 64, v88
  v_xor_b32 v91, 96, v88
  v_lshlrev_b32 v2, 3, v4
  v_and_b32 v3, 15, v1
  v_lshrrev_b32 v3, 2, v3
  v_add_u32 v2, v2, v3
  v_mul_u32_u24 v2, 128, v2
  v_lshrrev_b32 v3, 4, v1
  v_and_b32 v3, 1, v3
  v_lshl_add_u32 v2, v3, 5, v2
  v_and_b32 v3, 3, v1
  v_lshl_add_u32 v2, v3, 3, v2
  v_lshrrev_b32 v3, 3, v1
  v_and_b32 v3, 1, v3
  v_lshl_add_u32 v2, v3, 6, v2
  v_add_u32 v92, 12288, v2
  v_xor_b32 v93, 64, v92
  s_mov_b32 s45, 0
  s_mov_b32 s44, 0
  v_mov_b32 v8, 0
  v_mov_b32 v9, 0
  v_mov_b32 v10, 0
  v_mov_b32 v11, 0
  v_mov_b32 v12, 0
  v_mov_b32 v13, 0
  v_mov_b32 v14, 0
  v_mov_b32 v15, 0
  v_mov_b32 v16, 0
  v_mov_b32 v17, 0
  v_mov_b32 v18, 0
  v_mov_b32 v19, 0
  v_mov_b32 v20, 0
  v_mov_b32 v21, 0
  v_mov_b32 v22, 0
  v_mov_b32 v23, 0
  v_mov_b32 v24, 0
  v_mov_b32 v25, 0
  v_mov_b32 v26, 0
  v_mov_b32 v27, 0
  v_mov_b32 v28, 0
  v_mov_b32 v29, 0
  v_mov_b32 v30, 0
  v_mov_b32 v31, 0
  v_mov_b32 v32, 0
  v_mov_b32 v33, 0
  v_mov_b32 v34, 0
  v_mov_b32 v35, 0
  v_mov_b32 v36, 0
  v_mov_b32 v37, 0
  v_mov_b32 v38, 0
  v_mov_b32 v39, 0
  v_and_b32 v2, 31, v1
  s_lshl_b32 s47, s3, 5
  v_add_u32 v2, s47, v2
  v_lshrrev_b32 v3, 1, v2
  v_and_b32 v3, 7, v3
  v_lshlrev_b32 v3, 4, v3
  v_lshl_add_u32 v2, v2, 7, v3
  v_lshrrev_b32 v3, 5, v1
  v_lshl_add_u32 v2, v3, 3, v2
  v_add_u32 v144, 102400, v2
  s_waitcnt lgkmcnt(0)
  s_mov_b32 s16, s6
  s_mov_b32 s17, s7
  s_mov_b32 s18, 0x3c00
  s_mov_b32 s19, 0x00020000
  s_add_u32 s20, s6, 0x1100000
  s_addc_u32 s21, s7, 0
  s_mov_b32 s22, 0x280000
  s_mov_b32 s23, 0x00020000
  s_mov_b32 s64, s24
  s_mov_b32 s65, s25
  s_mov_b32 s66, 0x280000
  s_mov_b32 s67, 0x00020000
  s_movk_i32 s38, 12800
  buffer_load_dwordx4 v[96:99], v145, s[16:19], s38 offen offset:0
  buffer_load_dwordx4 v[100:103], v145, s[16:19], s38 offen offset:32
  buffer_load_dwordx4 v[104:107], v145, s[16:19], s38 offen offset:64
  buffer_load_dwordx4 v[108:111], v145, s[16:19], s38 offen offset:96
  buffer_load_dwordx4 v[112:115], v145, s[16:19], s38 offen offset:128
  buffer_load_dwordx4 v[116:119], v145, s[16:19], s38 offen offset:160
  buffer_load_dwordx4 v[120:123], v145, s[16:19], s38 offen offset:192
  buffer_load_dwordx4 v[124:127], v145, s[16:19], s38 offen offset:224
  s_lshl_b32 s48, s3, 12
  s_add_u32 m0, s48, 102400
  s_mov_b32 s49, 0
  buffer_load_dwordx4 v146, s[20:23], s49 offen lds
  s_add_u32 m0, s48, 103424
  s_mov_b32 s49, 10240
  buffer_load_dwordx4 v147, s[20:23], s49 offen lds
  s_add_u32 m0, s48, 104448
  s_mov_b32 s49, 20480
  buffer_load_dwordx4 v146, s[20:23], s49 offen lds
  s_add_u32 m0, s48, 105472
  s_mov_b32 s49, 30720
  buffer_load_dwordx4 v147, s[20:23], s49 offen lds
  s_barrier
  ds_read_b128 v[40:43], v88
  ds_read_b64_tr_b16 v[56:57], v92 offset:0
  ds_read_b64_tr_b16 v[58:59], v92 offset:512
  ds_read_b64_tr_b16 v[60:61], v93 offset:0
  ds_read_b64_tr_b16 v[62:63], v93 offset:512
  ds_read_b128 v[44:47], v89
  ds_read_b64_tr_b16 v[64:65], v92 offset:2048
  ds_read_b64_tr_b16 v[66:67], v92 offset:2560
  ds_read_b64_tr_b16 v[68:69], v93 offset:2048
  ds_read_b64_tr_b16 v[70:71], v93 offset:2560
  ds_read_b128 v[48:51], v90
  ds_read_b64_tr_b16 v[72:73], v92 offset:4096
  ds_read_b64_tr_b16 v[74:75], v92 offset:4608
  ds_read_b64_tr_b16 v[76:77], v93 offset:4096
  ds_read_b64_tr_b16 v[78:79], v93 offset:4608
p5_loop_2:
  s_waitcnt lgkmcnt(10)
  v_mfma_f32_32x32x16_bf16 v[8:23], v[56:59], v[40:43], v[8:23]
  ds_read_b128 v[52:55], v91
  ds_read_b64_tr_b16 v[80:81], v92 offset:6144
  ds_read_b64_tr_b16 v[82:83], v92 offset:6656
  v_mfma_f32_32x32x16_bf16 v[24:39], v[60:63], v[40:43], v[24:39]
  ds_read_b64_tr_b16 v[84:85], v93 offset:6144
  ds_read_b64_tr_b16 v[86:87], v93 offset:6656
  s_waitcnt lgkmcnt(10)
  s_barrier
  s_add_u32 s46, s45, 20480
  s_cmp_eq_u32 s46, 102400
  s_cselect_b32 s46, 0, s46
  s_sub_u32 s47, s46, s45
  s_mov_b32 s45, s46
  v_mfma_f32_32x32x16_bf16 v[8:23], v[64:67], v[44:47], v[8:23]
  v_add_u32 v88, s47, v88
  v_add_u32 v89, s47, v89
  v_add_u32 v90, s47, v90
  v_add_u32 v91, s47, v91
  v_add_u32 v92, s47, v92
  v_add_u32 v93, s47, v93
  ds_read_b128 v[40:43], v88
  ds_read_b64_tr_b16 v[56:57], v92 offset:0
  ds_read_b64_tr_b16 v[58:59], v92 offset:512
  v_mfma_f32_32x32x16_bf16 v[24:39], v[68:71], v[44:47], v[24:39]
  ds_read_b64_tr_b16 v[60:61], v93 offset:0
  ds_read_b64_tr_b16 v[62:63], v93 offset:512
  s_waitcnt lgkmcnt(10)
  v_mfma_f32_32x32x16_bf16 v[8:23], v[72:75], v[48:51], v[8:23]
  ds_read_b128 v[44:47], v89
  ds_read_b64_tr_b16 v[64:65], v92 offset:2048
  ds_read_b64_tr_b16 v[66:67], v92 offset:2560
  v_mfma_f32_32x32x16_bf16 v[24:39], v[76:79], v[48:51], v[24:39]
  ds_read_b64_tr_b16 v[68:69], v93 offset:2048
  ds_read_b64_tr_b16 v[70:71], v93 offset:2560
  s_waitcnt lgkmcnt(10)
  v_mfma_f32_32x32x16_bf16 v[8:23], v[80:83], v[52:55], v[8:23]
  ds_read_b128 v[48:51], v90
  ds_read_b64_tr_b16 v[72:73], v92 offset:4096
  ds_read_b64_tr_b16 v[74:75], v92 offset:4608
  v_mfma_f32_32x32x16_bf16 v[24:39], v[84:87], v[52:55], v[24:39]
  ds_read_b64_tr_b16 v[76:77], v93 offset:4096
  ds_read_b64_tr_b16 v[78:79], v93 offset:4608
  s_add_u32 s44, s44, 1
  s_cmp_lt_u32 s44, 26
  s_cbranch_scc1 p5_loop_2
  s_waitcnt lgkmcnt(10)
  v_mfma_f32_32x32x16_bf16 v[8:23], v[56:59], v[40:43], v[8:23]
  ds_read_b128 v[52:55], v91
  ds_read_b64_tr_b16 v[80:81], v92 offset:6144
  ds_read_b64_tr_b16 v[82:83], v92 offset:6656
  v_mfma_f32_32x32x16_bf16 v[24:39], v[60:63], v[40:43], v[24:39]
  ds_read_b64_tr_b16 v[84:85], v93 offset:6144
  ds_read_b64_tr_b16 v[86:87], v93 offset:6656
  s_waitcnt lgkmcnt(10)
  v_mfma_f32_32x32x16_bf16 v[8:23], v[64:67], v[44:47], v[8:23]
  v_mfma_f32_32x32x16_bf16 v[24:39], v[68:71], v[44:47], v[24:39]
  s_waitcnt lgkmcnt(5)
  v_mfma_f32_32x32x16_bf16 v[8:23], v[72:75], v[48:51], v[8:23]
  v_mfma_f32_32x32x16_bf16 v[24:39], v[76:79], v[48:51], v[24:39]
  s_waitcnt lgkmcnt(0)
  v_mfma_f32_32x32x16_bf16 v[8:23], v[80:83], v[52:55], v[8:23]
  v_mfma_f32_32x32x16_bf16 v[24:39], v[84:87], v[52:55], v[24:39]
  s_nop 15
  s_waitcnt vmcnt(0)
  v_xor_b32 v148, 0, v144
  ds_read_b64 v[128:129], v148
  v_xor_b32 v149, 16, v144
  ds_read_b64 v[130:131], v149
  v_xor_b32 v150, 32, v144
  ds_read_b64 v[132:133], v150
  v_xor_b32 v151, 48, v144
  ds_read_b64 v[134:135], v151
  v_xor_b32 v152, 64, v144
  ds_read_b64 v[136:137], v152
  v_xor_b32 v153, 80, v144
  ds_read_b64 v[138:139], v153
  v_xor_b32 v154, 96, v144
  ds_read_b64 v[140:141], v154
  v_xor_b32 v155, 112, v144
  ds_read_b64 v[142:143], v155
  s_waitcnt lgkmcnt(7)
  v_lshlrev_b32 v2, 16, v128
  v_and_b32 v3, 0xffff0000, v128
  v_pk_fma_f32 v[8:9], v[8:9], v[96:97], v[2:3]
  v_lshlrev_b32 v4, 16, v129
  v_and_b32 v5, 0xffff0000, v129
  v_pk_fma_f32 v[10:11], v[10:11], v[98:99], v[4:5]
  v_cvt_pk_bf16_f32 v128, v8, v9
  v_cvt_pk_bf16_f32 v129, v10, v11
  s_waitcnt lgkmcnt(6)
  v_lshlrev_b32 v2, 16, v130
  v_and_b32 v3, 0xffff0000, v130
  v_pk_fma_f32 v[12:13], v[12:13], v[100:101], v[2:3]
  v_lshlrev_b32 v4, 16, v131
  v_and_b32 v5, 0xffff0000, v131
  v_pk_fma_f32 v[14:15], v[14:15], v[102:103], v[4:5]
  v_cvt_pk_bf16_f32 v130, v12, v13
  v_cvt_pk_bf16_f32 v131, v14, v15
  s_waitcnt lgkmcnt(5)
  v_lshlrev_b32 v2, 16, v132
  v_and_b32 v3, 0xffff0000, v132
  v_pk_fma_f32 v[16:17], v[16:17], v[104:105], v[2:3]
  v_lshlrev_b32 v4, 16, v133
  v_and_b32 v5, 0xffff0000, v133
  v_pk_fma_f32 v[18:19], v[18:19], v[106:107], v[4:5]
  v_cvt_pk_bf16_f32 v132, v16, v17
  v_cvt_pk_bf16_f32 v133, v18, v19
  s_waitcnt lgkmcnt(4)
  v_lshlrev_b32 v2, 16, v134
  v_and_b32 v3, 0xffff0000, v134
  v_pk_fma_f32 v[20:21], v[20:21], v[108:109], v[2:3]
  v_lshlrev_b32 v4, 16, v135
  v_and_b32 v5, 0xffff0000, v135
  v_pk_fma_f32 v[22:23], v[22:23], v[110:111], v[4:5]
  v_cvt_pk_bf16_f32 v134, v20, v21
  v_cvt_pk_bf16_f32 v135, v22, v23
  s_waitcnt lgkmcnt(3)
  v_lshlrev_b32 v2, 16, v136
  v_and_b32 v3, 0xffff0000, v136
  v_pk_fma_f32 v[24:25], v[24:25], v[112:113], v[2:3]
  v_lshlrev_b32 v4, 16, v137
  v_and_b32 v5, 0xffff0000, v137
  v_pk_fma_f32 v[26:27], v[26:27], v[114:115], v[4:5]
  v_cvt_pk_bf16_f32 v136, v24, v25
  v_cvt_pk_bf16_f32 v137, v26, v27
  s_waitcnt lgkmcnt(2)
  v_lshlrev_b32 v2, 16, v138
  v_and_b32 v3, 0xffff0000, v138
  v_pk_fma_f32 v[28:29], v[28:29], v[116:117], v[2:3]
  v_lshlrev_b32 v4, 16, v139
  v_and_b32 v5, 0xffff0000, v139
  v_pk_fma_f32 v[30:31], v[30:31], v[118:119], v[4:5]
  v_cvt_pk_bf16_f32 v138, v28, v29
  v_cvt_pk_bf16_f32 v139, v30, v31
  s_waitcnt lgkmcnt(1)
  v_lshlrev_b32 v2, 16, v140
  v_and_b32 v3, 0xffff0000, v140
  v_pk_fma_f32 v[32:33], v[32:33], v[120:121], v[2:3]
  v_lshlrev_b32 v4, 16, v141
  v_and_b32 v5, 0xffff0000, v141
  v_pk_fma_f32 v[34:35], v[34:35], v[122:123], v[4:5]
  v_cvt_pk_bf16_f32 v140, v32, v33
  v_cvt_pk_bf16_f32 v141, v34, v35
  s_waitcnt lgkmcnt(0)
  v_lshlrev_b32 v2, 16, v142
  v_and_b32 v3, 0xffff0000, v142
  v_pk_fma_f32 v[36:37], v[36:37], v[124:125], v[2:3]
  v_lshlrev_b32 v4, 16, v143
  v_and_b32 v5, 0xffff0000, v143
  v_pk_fma_f32 v[38:39], v[38:39], v[126:127], v[4:5]
  v_cvt_pk_bf16_f32 v142, v36, v37
  v_cvt_pk_bf16_f32 v143, v38, v39
  ds_write_b64 v148, v[128:129]
  ds_write_b64 v149, v[130:131]
  ds_write_b64 v150, v[132:133]
  ds_write_b64 v151, v[134:135]
  ds_write_b64 v152, v[136:137]
  ds_write_b64 v153, v[138:139]
  ds_write_b64 v154, v[140:141]
  ds_write_b64 v155, v[142:143]
  s_lshl_b32 s48, s3, 12
  s_add_u32 s48, s48, 102400
  v_lshlrev_b32 v2, 4, v1
  v_add_u32 v2, s48, v2
  s_waitcnt lgkmcnt(0)
  ds_read_b128 v[96:99], v2 offset:0
  ds_read_b128 v[100:103], v2 offset:1024
  ds_read_b128 v[104:107], v2 offset:2048
  ds_read_b128 v[108:111], v2 offset:3072
  s_mov_b32 s49, 0
  s_waitcnt lgkmcnt(3)
  buffer_store_dwordx4 v[96:99], v146, s[64:67], s49 offen
  s_mov_b32 s49, 10240
  s_waitcnt lgkmcnt(2)
  buffer_store_dwordx4 v[100:103], v147, s[64:67], s49 offen
  s_mov_b32 s49, 20480
  s_waitcnt lgkmcnt(1)
  buffer_store_dwordx4 v[104:107], v146, s[64:67], s49 offen
  s_mov_b32 s49, 30720
  s_waitcnt lgkmcnt(0)
  buffer_store_dwordx4 v[108:111], v147, s[64:67], s49 offen
p5_END:
  s_endpgm
.section .rodata,"a"
.p2align 6
.amdhsa_kernel p5_kernel
  .amdhsa_next_free_vgpr 160
  .amdhsa_next_free_sgpr 102
  .amdhsa_accum_offset 160
  .amdhsa_group_segment_fixed_size 0
  .amdhsa_kernarg_size 96
  .amdhsa_user_sgpr_count 2
  .amdhsa_user_sgpr_kernarg_segment_ptr 1
  .amdhsa_system_sgpr_workgroup_id_x 1
.end_amdhsa_kernel
```
